```python
import torch

def _softmax(x, axis=-1):
    return torch.softmax(x, dim=axis)
def _gelu(x):
    return torch.nn.functional.gelu(x, approximate="tanh")
def _silu(x):
    return torch.nn.functional.silu(x)
def _sigmoid(x):
    return torch.sigmoid(x)
def _layernorm(x, axis=-1, eps=1e-5):
    m = x.mean(dim=axis, keepdim=True)
    v = x.var(dim=axis, keepdim=True, unbiased=False)
    return (x - m) / torch.sqrt(v + eps)
def _scatter_add(tgt, idx, src, axis=0):
    return tgt.clone().index_add_(axis, idx, src)
def _segment_sum(src, seg, n):
    out = torch.zeros((n,) + src.shape[1:], dtype=src.dtype)
    return out.index_add_(0, seg, src)
def _pad(x, pw):
    flat = tuple(v for pair in reversed(pw) for v in pair)
    return torch.nn.functional.pad(x, flat)

kernel_name = 'gated_mix__mha_block__geglu_ffn__prompt'

def setup_inputs():

    _w = (lambda a: (lambda t: t.to(torch.bfloat16) if t.is_floating_point() else t)(torch.as_tensor(a)))
    def _A_setup():
        B, S, D, H = 1, 2048, 448, 16
        return {
            "x": _w((lambda *s: torch.randn(*s, dtype=torch.bfloat16) * 0.05)(B, S, D)),
            "wqkv": _w((lambda *s: torch.randn(*s, dtype=torch.bfloat16) * 0.8)(D, 3 * D)),
            "wo": _w((lambda *s: torch.randn(*s, dtype=torch.bfloat16) * 0.05)(D, D)),
        }
    _A_in = _A_setup()

    def _B_setup():
        B, S, D, F = 1, 2048, 448, 1792
        return {
            "x": _w((lambda *s: torch.randn(*s, dtype=torch.bfloat16) * 0.05)(B, S, D)),
            "w_gate": _w((lambda *s: torch.randn(*s, dtype=torch.bfloat16) * 0.1)(D, F)),
            "w_up": _w((lambda *s: torch.randn(*s, dtype=torch.bfloat16) * 0.1)(D, F)),
            "w_down": _w((lambda *s: torch.randn(*s, dtype=torch.bfloat16) * 0.1)(F, D)),
        }
    _B_in = _B_setup()

    return {
        "A_x": _A_in["x"],
        "A_wqkv": _A_in["wqkv"],
        "A_wo": _A_in["wo"],
        "B_x": _B_in["x"],
        "B_w_gate": _B_in["w_gate"],
        "B_w_up": _B_in["w_up"],
        "B_w_down": _B_in["w_down"],
        "gate_w": _w((lambda *s: torch.randn(*s, dtype=torch.bfloat16) * 0.05)(448) * 16.0),
    }

def reference(A_x, A_wqkv, A_wo, B_x, B_w_gate, B_w_up, B_w_down, gate_w):
    def _A_ref(x, wqkv, wo):
        B, S, D = x.shape
        H = 16
        Dh = D // H
        qkv = (lambda x, *d: x.permute(*d))((x @ wqkv).reshape(B, S, 3, H, Dh), 2, 0, 3, 1, 4)
        q, k, v = qkv[0], qkv[1], qkv[2]
        scores = torch.einsum("bhqd,bhkd->bhqk", q, k) * (Dh ** -0.5)
        p = _softmax(scores, axis=-1)
        o = torch.einsum("bhqk,bhkd->bhqd", p, v)
        return (lambda x, *d: x.permute(*d))(o, 0, 2, 1, 3).reshape(B, S, D) @ wo

    def _B_ref(x, w_gate, w_up, w_down):
        return (_gelu(x @ w_gate) * (x @ w_up)) @ w_down

    x = A_x
    g = _sigmoid((x * gate_w).sum(-1, keepdims=True))
    a = _A_ref(x, A_wqkv, A_wo)
    b = _B_ref(x, B_w_gate, B_w_up, B_w_down)
    return g * a + (1 - g) * b
```

```asm
; @launch grid=(256,1,1) block=(768,1,1) lds=163840
.amdgcn_target "amdgcn-amd-amdhsa--gfx950"
.text
.globl gated_mix__mha_block__geglu_ffn__prompt_kernel
.p2align 8
.type gated_mix__mha_block__geglu_ffn__prompt_kernel,@function
gated_mix__mha_block__geglu_ffn__prompt_kernel:
    s_cmp_ge_u32 s2, 256
    s_cbranch_scc1 L_END
    s_load_dwordx16 s[4:19], s[0:1], 0
    s_load_dwordx4 s[20:23], s[0:1], 64
    s_load_dwordx2 s[24:25], s[0:1], 80
    v_lshrrev_b32 v2, 6, v0
    v_and_b32 v1, 63, v0
    s_and_b32 s27, s2, 7
    v_readfirstlane_b32 s26, v2
    s_lshr_b32 s48, s2, 3
    s_and_b32 s56, s48, 7
    s_lshr_b32 s3, s27, 2
    s_lshl_b32 s3, s3, 3
    s_add_u32 s56, s56, s3
    s_lshr_b32 s57, s48, 3
    s_and_b32 s3, s27, 3
    s_lshl_b32 s3, s3, 2
    s_add_u32 s57, s57, s3
    s_cmp_ge_u32 s57, 14
    s_cselect_b32 s58, 1, 0
    s_mul_i32 s59, s57, 3
    v_lshlrev_b32 v9, 4, v1
    s_mov_b32 s52, 0
    s_mov_b32 s53, -1
    s_cmp_ge_u32 s26, 1
    s_cbranch_scc1 EP_1
    s_getpc_b64 s[36:37]
EP_PC:
    s_and_b32 s3, s48, 3
    s_mul_i32 s3, s3, 1
    s_add_u32 s3, s3, s26
    s_lshl_b32 s3, s3, 13
    v_lshlrev_b32 v158, 7, v1
    v_add_u32 v158, s3, v158
    v_min_u32 v158, L_CODE_END-EP_PC-4, v158
    global_load_dword v159, v158, s[36:37]
EP_1:
    s_cmp_lt_u32 s26, 8
    s_cbranch_scc1 L_COMPUTE
L_AUX:
    s_setprio 3
    s_sub_u32 s49, s26, 8
    s_lshl_b32 s3, s56, 7
    s_lshl_b32 s66, s49, 5
    s_add_u32 s3, s3, s66
    v_lshrrev_b32 v2, 3, v1
    v_and_b32 v3, 7, v1
    v_lshrrev_b32 v4, 4, v1
    v_add_u32 v5, s3, v2
    v_mul_u32_u24 v5, 896, v5
    v_xor_b32 v6, v3, v4
    v_lshl_add_u32 v10, v6, 4, v5
    v_xor_b32 v6, 4, v6
    v_lshl_add_u32 v11, v6, 4, v5
    v_add_u32 v11, 6144, v11
    s_lshl_b32 s3, s49, 4
    v_lshrrev_b32 v4, 2, v1
    v_add_u32 v4, s3, v4
    v_mul_u32_u24 v4, 2688, v4
    v_and_b32 v5, 3, v1
    v_lshl_add_u32 v4, v5, 4, v4
    s_mul_i32 s65, s59, 56
    v_add_u32 v12, s65, v4
    s_lshl_b32 s62, s49, 12
    s_lshl_b32 s63, s49, 10
    s_add_u32 s63, s63, 114688
    s_lshr_b32 s68, s48, 3
    s_mul_i32 s68, s68, 2
    s_and_b32 s3, s48, 7
    s_add_u32 s68, s68, s3
    s_sub_u32 s3, s68, 7
    s_cmp_ge_u32 s68, 7
    s_cselect_b32 s68, s3, s68
    s_sub_u32 s3, s68, 7
    s_cmp_ge_u32 s68, 7
    s_cselect_b32 s68, s3, s68
    s_lshl_b32 s3, s68, 2
    s_mov_b32 s68, 0x6543210
    s_mov_b32 s69, 0x654321
    s_lshr_b64 s[68:69], s[68:69], s3
    s_lshl_b32 s68, s68, 0
    s_waitcnt lgkmcnt(0)
    s_mov_b32 s32, s4
    s_and_b32 s33, s5, 0xffff
    s_mov_b32 s34, 1835008
    s_mov_b32 s35, 0x20000
    s_mov_b32 s44, s6
    s_and_b32 s45, s7, 0xffff
    s_mov_b32 s46, 1204224
    s_mov_b32 s47, 0x20000
    s_bfe_u32 s37, s68, 0x40000
    s_mul_i32 s36, s37, 172032
    s_add_u32 m0, s63, 0
    s_add_u32 s3, s36, 0
    buffer_load_dwordx4 v12, s[44:47], s3 offen lds
    s_add_u32 m0, s63, 4096
    s_add_u32 s3, s36, 56
    buffer_load_dwordx4 v12, s[44:47], s3 offen lds
    s_add_u32 m0, s63, 8192
    s_add_u32 s3, s36, 112
    buffer_load_dwordx4 v12, s[44:47], s3 offen lds
    s_add_u32 m0, s62, 0
    s_lshl_b32 s3, s37, 7
    buffer_load_dwordx4 v10, s[32:35], s3 offen offset:0 lds
    buffer_load_dwordx4 v11, s[32:35], s3 offen offset:1024 lds
    s_add_u32 s3, s3, 12288
    buffer_load_dwordx4 v10, s[32:35], s3 offen offset:2048 lds
    buffer_load_dwordx4 v11, s[32:35], s3 offen offset:3072 lds
    s_bfe_u32 s37, s68, 0x40004
    s_mul_i32 s36, s37, 172032
    s_add_u32 m0, s63, 16384
    s_add_u32 s3, s36, 0
    buffer_load_dwordx4 v12, s[44:47], s3 offen lds
    s_add_u32 m0, s63, 20480
    s_add_u32 s3, s36, 56
    buffer_load_dwordx4 v12, s[44:47], s3 offen lds
    s_add_u32 m0, s63, 24576
    s_add_u32 s3, s36, 112
    buffer_load_dwordx4 v12, s[44:47], s3 offen lds
    s_add_u32 m0, s62, 16384
    s_lshl_b32 s3, s37, 7
    buffer_load_dwordx4 v10, s[32:35], s3 offen offset:0 lds
    buffer_load_dwordx4 v11, s[32:35], s3 offen offset:1024 lds
    s_add_u32 s3, s3, 12288
    buffer_load_dwordx4 v10, s[32:35], s3 offen offset:2048 lds
    buffer_load_dwordx4 v11, s[32:35], s3 offen offset:3072 lds
    v_mul_u32_u24 v4, 3584, v2
    v_lshrrev_b32 v5, 1, v3
    v_and_b32 v6, 2, v2
    v_xor_b32 v5, v5, v6
    s_lshr_b32 s3, s49, 1
    v_xor_b32 v5, s3, v5
    v_lshl_add_u32 v4, v5, 5, v4
    v_and_b32 v7, 1, v3
    v_lshl_add_u32 v4, v7, 4, v4
    s_lshl_b32 s64, s57, 1
    s_and_b32 s65, s49, 1
    s_add_u32 s64, s64, s65
    s_lshl_b32 s64, s64, 7
    v_add_u32 v13, s64, v4
    s_cmp_ge_u32 s49, 2
    s_cselect_b64 s[12:13], s[14:15], s[12:13]
    s_cmp_eq_u32 s58, 1
    s_cselect_b32 s66, 0, 1605632
    s_mov_b32 s40, s12
    s_and_b32 s41, s13, 0xffff
    s_mov_b32 s42, s66
    s_mov_b32 s43, 0x20000
    s_mov_b32 s28, s24
    s_and_b32 s29, s25, 0xffff
    s_mov_b32 s30, 25165824
    s_mov_b32 s31, 0x20000
    s_waitcnt vmcnt(7)
    s_barrier
    s_bfe_u32 s37, s68, 0x40008
    s_mul_i32 s36, s37, 172032
    s_add_u32 m0, s63, 32768
    s_add_u32 s3, s36, 0
    buffer_load_dwordx4 v12, s[44:47], s3 offen lds
    s_add_u32 m0, s63, 36864
    s_add_u32 s3, s36, 56
    buffer_load_dwordx4 v12, s[44:47], s3 offen lds
    s_add_u32 m0, s63, 40960
    s_add_u32 s3, s36, 112
    buffer_load_dwordx4 v12, s[44:47], s3 offen lds
    s_add_u32 m0, s62, 32768
    s_lshl_b32 s3, s37, 7
    buffer_load_dwordx4 v10, s[32:35], s3 offen offset:0 lds
    buffer_load_dwordx4 v11, s[32:35], s3 offen offset:1024 lds
    s_add_u32 s3, s3, 12288
    buffer_load_dwordx4 v10, s[32:35], s3 offen offset:2048 lds
    buffer_load_dwordx4 v11, s[32:35], s3 offen offset:3072 lds
    s_waitcnt vmcnt(7)
    s_barrier
    s_bfe_u32 s37, s68, 0x4000c
    s_mul_i32 s36, s37, 172032
    s_add_u32 m0, s63, 0
    s_add_u32 s3, s36, 0
    buffer_load_dwordx4 v12, s[44:47], s3 offen lds
    s_add_u32 m0, s63, 4096
    s_add_u32 s3, s36, 56
    buffer_load_dwordx4 v12, s[44:47], s3 offen lds
    s_add_u32 m0, s63, 8192
    s_add_u32 s3, s36, 112
    buffer_load_dwordx4 v12, s[44:47], s3 offen lds
    s_add_u32 m0, s62, 49152
    s_lshl_b32 s3, s37, 7
    buffer_load_dwordx4 v10, s[32:35], s3 offen offset:0 lds
    buffer_load_dwordx4 v11, s[32:35], s3 offen offset:1024 lds
    s_add_u32 s3, s3, 12288
    buffer_load_dwordx4 v10, s[32:35], s3 offen offset:2048 lds
    buffer_load_dwordx4 v11, s[32:35], s3 offen offset:3072 lds
    s_waitcnt vmcnt(7)
    s_barrier
    s_bfe_u32 s37, s68, 0x40010
    s_mul_i32 s36, s37, 172032
    s_add_u32 m0, s63, 16384
    s_add_u32 s3, s36, 0
    buffer_load_dwordx4 v12, s[44:47], s3 offen lds
    s_add_u32 m0, s63, 20480
    s_add_u32 s3, s36, 56
    buffer_load_dwordx4 v12, s[44:47], s3 offen lds
    s_add_u32 m0, s63, 24576
    s_add_u32 s3, s36, 112
    buffer_load_dwordx4 v12, s[44:47], s3 offen lds
    s_add_u32 m0, s62, 65536
    s_lshl_b32 s3, s37, 7
    buffer_load_dwordx4 v10, s[32:35], s3 offen offset:0 lds
    buffer_load_dwordx4 v11, s[32:35], s3 offen offset:1024 lds
    s_add_u32 s3, s3, 12288
    buffer_load_dwordx4 v10, s[32:35], s3 offen offset:2048 lds
    buffer_load_dwordx4 v11, s[32:35], s3 offen offset:3072 lds
    s_waitcnt vmcnt(7)
    s_barrier
    s_bfe_u32 s37, s68, 0x40014
    s_mul_i32 s36, s37, 172032
    s_add_u32 m0, s63, 32768
    s_add_u32 s3, s36, 0
    buffer_load_dwordx4 v12, s[44:47], s3 offen lds
    s_add_u32 m0, s63, 36864
    s_add_u32 s3, s36, 56
    buffer_load_dwordx4 v12, s[44:47], s3 offen lds
    s_add_u32 m0, s63, 40960
    s_add_u32 s3, s36, 112
    buffer_load_dwordx4 v12, s[44:47], s3 offen lds
    s_add_u32 m0, s62, 81920
    s_lshl_b32 s3, s37, 7
    buffer_load_dwordx4 v10, s[32:35], s3 offen offset:0 lds
    buffer_load_dwordx4 v11, s[32:35], s3 offen offset:1024 lds
    s_add_u32 s3, s3, 12288
    buffer_load_dwordx4 v10, s[32:35], s3 offen offset:2048 lds
    buffer_load_dwordx4 v11, s[32:35], s3 offen offset:3072 lds
    s_waitcnt vmcnt(7)
    s_barrier
    s_bfe_u32 s37, s68, 0x40018
    s_mul_i32 s36, s37, 172032
    s_add_u32 m0, s63, 0
    s_add_u32 s3, s36, 0
    buffer_load_dwordx4 v12, s[44:47], s3 offen lds
    s_add_u32 m0, s63, 4096
    s_add_u32 s3, s36, 56
    buffer_load_dwordx4 v12, s[44:47], s3 offen lds
    s_add_u32 m0, s63, 8192
    s_add_u32 s3, s36, 112
    buffer_load_dwordx4 v12, s[44:47], s3 offen lds
    s_add_u32 m0, s62, 98304
    s_lshl_b32 s3, s37, 7
    buffer_load_dwordx4 v10, s[32:35], s3 offen offset:0 lds
    buffer_load_dwordx4 v11, s[32:35], s3 offen offset:1024 lds
    s_add_u32 s3, s3, 12288
    buffer_load_dwordx4 v10, s[32:35], s3 offen offset:2048 lds
    buffer_load_dwordx4 v11, s[32:35], s3 offen offset:3072 lds
    s_waitcnt vmcnt(7)
    s_barrier
    s_add_u32 m0, s62, 131072
    s_bfe_u32 s37, s68, 0x40000
    s_mul_i32 s3, s37, 229376
    buffer_load_dwordx4 v13, s[40:43], s3 offen offset:0 lds
    s_add_u32 s3, s3, 27648
    buffer_load_dwordx4 v13, s[40:43], s3 offen offset:1024 lds
    s_add_u32 s3, s3, 27648
    buffer_load_dwordx4 v13, s[40:43], s3 offen offset:2048 lds
    s_add_u32 s3, s3, 27648
    buffer_load_dwordx4 v13, s[40:43], s3 offen offset:3072 lds
    s_waitcnt vmcnt(4)
    s_barrier
    s_add_u32 m0, s62, 147456
    s_bfe_u32 s37, s68, 0x40000
    s_mul_i32 s3, s37, 229376
    s_add_u32 s3, s3, 114688
    buffer_load_dwordx4 v13, s[40:43], s3 offen offset:0 lds
    s_add_u32 s3, s3, 27648
    buffer_load_dwordx4 v13, s[40:43], s3 offen offset:1024 lds
    s_add_u32 s3, s3, 27648
    buffer_load_dwordx4 v13, s[40:43], s3 offen offset:2048 lds
    s_add_u32 s3, s3, 27648
    buffer_load_dwordx4 v13, s[40:43], s3 offen offset:3072 lds
    s_lshr_b32 s60, s48, 4
    s_lshl_b32 s3, s27, 1
    s_add_u32 s60, s60, s3
    s_lshl_b32 s38, s60, 18
    s_add_u32 s38, s38, 2097152
    s_lshl_b32 s39, s49, 13
    v_add_u32 v8, s39, v9
    v_mov_b32 v2, 0
    s_and_b32 s59, s48, 15
    s_lshl_b32 s59, s59, 2
    s_add_u32 s59, s59, s49
    s_lshl_b32 s61, s60, 2
    s_add_u32 s61, s61, s49
    s_mul_i32 s61, s61, 4352
    s_add_u32 s61, s61, 22020096
    v_lshlrev_b32 v3, 3, v1
    v_add_u32 v3, s61, v3
    s_mul_i32 s61, s60, 4352
    s_lshr_b32 s58, s59, 1
    s_lshl_b32 s3, s59, 3
    s_add_u32 s61, s61, s3
    s_add_u32 s61, s61, 22298624
    v_mov_b32 v4, s61
    v_cmp_gt_u32 vcc, 32, v1
    s_mul_i32 s58, s58, 4352
    s_lshl_b32 s54, s60, 6
    v_cndmask_b32 v15, v4, v3, vcc
    s_add_u32 s54, s54, s59
    s_lshl_b32 s54, s54, 11
    s_add_u32 s54, s54, 0
    s_lshl_b32 s55, s49, 11
    s_add_u32 s55, s55, 65536
    s_mov_b32 s67, 0
    s_waitcnt vmcnt(4)
    s_barrier
    s_add_u32 m0, s62, 114688
    s_bfe_u32 s37, s68, 0x40004
    s_mul_i32 s3, s37, 229376
    buffer_load_dwordx4 v13, s[40:43], s3 offen offset:0 lds
    s_add_u32 s3, s3, 27648
    buffer_load_dwordx4 v13, s[40:43], s3 offen offset:1024 lds
    s_add_u32 s3, s3, 27648
    buffer_load_dwordx4 v13, s[40:43], s3 offen offset:2048 lds
    s_add_u32 s3, s3, 27648
    buffer_load_dwordx4 v13, s[40:43], s3 offen offset:3072 lds
    global_load_dwordx2 v[164:165], v2, s[22:23] sc1
    s_waitcnt vmcnt(5)
    s_barrier
    s_add_u32 m0, s62, 131072
    s_bfe_u32 s37, s68, 0x40004
    s_mul_i32 s3, s37, 229376
    s_add_u32 s3, s3, 114688
    buffer_load_dwordx4 v13, s[40:43], s3 offen offset:0 lds
    s_add_u32 s3, s3, 27648
    buffer_load_dwordx4 v13, s[40:43], s3 offen offset:1024 lds
    s_add_u32 s3, s3, 27648
    buffer_load_dwordx4 v13, s[40:43], s3 offen offset:2048 lds
    s_add_u32 s3, s3, 27648
    buffer_load_dwordx4 v13, s[40:43], s3 offen offset:3072 lds
    s_waitcnt vmcnt(4)
    s_barrier
    s_add_u32 m0, s62, 147456
    s_bfe_u32 s37, s68, 0x40008
    s_mul_i32 s3, s37, 229376
    buffer_load_dwordx4 v13, s[40:43], s3 offen offset:0 lds
    s_add_u32 s3, s3, 27648
    buffer_load_dwordx4 v13, s[40:43], s3 offen offset:1024 lds
    s_add_u32 s3, s3, 27648
    buffer_load_dwordx4 v13, s[40:43], s3 offen offset:2048 lds
    s_add_u32 s3, s3, 27648
    buffer_load_dwordx4 v13, s[40:43], s3 offen offset:3072 lds
    s_add_u32 m0, s62, 0
    s_bfe_u32 s37, s68, 0x40008
    s_mul_i32 s3, s37, 229376
    s_add_u32 s3, s3, 114688
    buffer_load_dwordx4 v13, s[40:43], s3 offen offset:0 lds
    s_add_u32 s3, s3, 27648
    buffer_load_dwordx4 v13, s[40:43], s3 offen offset:1024 lds
    s_add_u32 s3, s3, 27648
    buffer_load_dwordx4 v13, s[40:43], s3 offen offset:2048 lds
    s_add_u32 s3, s3, 27648
    buffer_load_dwordx4 v13, s[40:43], s3 offen offset:3072 lds
    s_waitcnt vmcnt(8)
    s_barrier
    s_add_u32 m0, s62, 114688
    s_bfe_u32 s37, s68, 0x4000c
    s_mul_i32 s3, s37, 229376
    buffer_load_dwordx4 v13, s[40:43], s3 offen offset:0 lds
    s_add_u32 s3, s3, 27648
    buffer_load_dwordx4 v13, s[40:43], s3 offen offset:1024 lds
    s_add_u32 s3, s3, 27648
    buffer_load_dwordx4 v13, s[40:43], s3 offen offset:2048 lds
    s_add_u32 s3, s3, 27648
    buffer_load_dwordx4 v13, s[40:43], s3 offen offset:3072 lds
    s_waitcnt vmcnt(8)
    s_barrier
    s_add_u32 m0, s62, 131072
    s_bfe_u32 s37, s68, 0x4000c
    s_mul_i32 s3, s37, 229376
    s_add_u32 s3, s3, 114688
    buffer_load_dwordx4 v13, s[40:43], s3 offen offset:0 lds
    s_add_u32 s3, s3, 27648
    buffer_load_dwordx4 v13, s[40:43], s3 offen offset:1024 lds
    s_add_u32 s3, s3, 27648
    buffer_load_dwordx4 v13, s[40:43], s3 offen offset:2048 lds
    s_add_u32 s3, s3, 27648
    buffer_load_dwordx4 v13, s[40:43], s3 offen offset:3072 lds
    s_add_u32 m0, s62, 16384
    s_bfe_u32 s37, s68, 0x40010
    s_mul_i32 s3, s37, 229376
    buffer_load_dwordx4 v13, s[40:43], s3 offen offset:0 lds
    s_add_u32 s3, s3, 27648
    buffer_load_dwordx4 v13, s[40:43], s3 offen offset:1024 lds
    s_add_u32 s3, s3, 27648
    buffer_load_dwordx4 v13, s[40:43], s3 offen offset:2048 lds
    s_add_u32 s3, s3, 27648
    buffer_load_dwordx4 v13, s[40:43], s3 offen offset:3072 lds
    s_waitcnt vmcnt(12)
    s_barrier
    s_add_u32 m0, s62, 147456
    s_bfe_u32 s37, s68, 0x40010
    s_mul_i32 s3, s37, 229376
    s_add_u32 s3, s3, 114688
    buffer_load_dwordx4 v13, s[40:43], s3 offen offset:0 lds
    s_add_u32 s3, s3, 27648
    buffer_load_dwordx4 v13, s[40:43], s3 offen offset:1024 lds
    s_add_u32 s3, s3, 27648
    buffer_load_dwordx4 v13, s[40:43], s3 offen offset:2048 lds
    s_add_u32 s3, s3, 27648
    buffer_load_dwordx4 v13, s[40:43], s3 offen offset:3072 lds
    s_waitcnt vmcnt(12)
    s_barrier
    s_add_u32 m0, s62, 32768
    s_bfe_u32 s37, s68, 0x40014
    s_mul_i32 s3, s37, 229376
    buffer_load_dwordx4 v13, s[40:43], s3 offen offset:0 lds
    s_add_u32 s3, s3, 27648
    buffer_load_dwordx4 v13, s[40:43], s3 offen offset:1024 lds
    s_add_u32 s3, s3, 27648
    buffer_load_dwordx4 v13, s[40:43], s3 offen offset:2048 lds
    s_add_u32 s3, s3, 27648
    buffer_load_dwordx4 v13, s[40:43], s3 offen offset:3072 lds
    s_waitcnt vmcnt(12)
    s_barrier
    s_add_u32 m0, s62, 114688
    s_bfe_u32 s37, s68, 0x40014
    s_mul_i32 s3, s37, 229376
    s_add_u32 s3, s3, 114688
    buffer_load_dwordx4 v13, s[40:43], s3 offen offset:0 lds
    s_add_u32 s3, s3, 27648
    buffer_load_dwordx4 v13, s[40:43], s3 offen offset:1024 lds
    s_add_u32 s3, s3, 27648
    buffer_load_dwordx4 v13, s[40:43], s3 offen offset:2048 lds
    s_add_u32 s3, s3, 27648
    buffer_load_dwordx4 v13, s[40:43], s3 offen offset:3072 lds
    s_waitcnt vmcnt(8)
    s_barrier
    s_add_u32 m0, s62, 131072
    s_bfe_u32 s37, s68, 0x40018
    s_mul_i32 s3, s37, 229376
    buffer_load_dwordx4 v13, s[40:43], s3 offen offset:0 lds
    s_add_u32 s3, s3, 27648
    buffer_load_dwordx4 v13, s[40:43], s3 offen offset:1024 lds
    s_add_u32 s3, s3, 27648
    buffer_load_dwordx4 v13, s[40:43], s3 offen offset:2048 lds
    s_add_u32 s3, s3, 27648
    buffer_load_dwordx4 v13, s[40:43], s3 offen offset:3072 lds
    s_add_u32 m0, s62, 49152
    s_bfe_u32 s37, s68, 0x40018
    s_mul_i32 s3, s37, 229376
    s_add_u32 s3, s3, 114688
    buffer_load_dwordx4 v13, s[40:43], s3 offen offset:0 lds
    s_add_u32 s3, s3, 27648
    buffer_load_dwordx4 v13, s[40:43], s3 offen offset:1024 lds
    s_add_u32 s3, s3, 27648
    buffer_load_dwordx4 v13, s[40:43], s3 offen offset:2048 lds
    s_add_u32 s3, s3, 27648
    buffer_load_dwordx4 v13, s[40:43], s3 offen offset:3072 lds
    s_waitcnt vmcnt(0)
    s_barrier
    s_mov_b32 s69, 0x40000
NLOOP_2:
    v_cmp_ne_u32 vcc, 0, v164
    s_sub_u32 s69, s69, 1
    s_cbranch_scc1 NDONE_3
    s_cbranch_vccnz NDONE_3
    global_load_dwordx2 v[164:165], v2, s[22:23] sc1
    s_waitcnt vmcnt(0)
    s_branch NLOOP_2
NDONE_3:
    v_readfirstlane_b32 s50, v164
    v_readfirstlane_b32 s51, v165
    s_mov_b32 s69, 0x40000
POLL_4:
    buffer_load_dwordx2 v[16:17], v15, s[28:31], s52 offen sc1
    s_waitcnt vmcnt(0)
    v_cmp_eq_u64 vcc, s[50:51], v[16:17]
    s_sub_u32 s69, s69, 1
    s_cbranch_scc1 POLLD_5
    s_cmp_eq_u64 vcc, -1
    s_cbranch_scc1 POLLD_5
    s_sleep 4
    s_branch POLL_4
POLLD_5:
    s_mov_b32 m0, s55
    s_nop 0
    buffer_load_dwordx4 v9, s[28:31], s54 offen sc1 lds
    buffer_load_dwordx4 v9, s[28:31], s54 offen offset:1024 sc1 lds
    s_mov_b32 s3, 0
    s_and_b32 s3, s3, 7
    s_lshl_b32 s3, s3, 15
    s_add_u32 s3, s3, s38
    s_add_u32 m0, s39, 0
    s_add_u32 s3, s3, 0
    buffer_load_dwordx4 v8, s[28:31], s3 offen offset:0 sc1 lds
    buffer_load_dwordx4 v8, s[28:31], s3 offen offset:1024 sc1 lds
    buffer_load_dwordx4 v8, s[28:31], s3 offen offset:2048 sc1 lds
    buffer_load_dwordx4 v8, s[28:31], s3 offen offset:3072 sc1 lds
    s_add_u32 m0, s39, 4096
    s_add_u32 s3, s3, 4096
    buffer_load_dwordx4 v8, s[28:31], s3 offen offset:0 sc1 lds
    buffer_load_dwordx4 v8, s[28:31], s3 offen offset:1024 sc1 lds
    buffer_load_dwordx4 v8, s[28:31], s3 offen offset:2048 sc1 lds
    buffer_load_dwordx4 v8, s[28:31], s3 offen offset:3072 sc1 lds
    s_waitcnt vmcnt(0)
    s_barrier
    s_mov_b32 s3, 1
    s_and_b32 s3, s3, 7
    s_lshl_b32 s3, s3, 15
    s_add_u32 s3, s3, s38
    s_add_u32 m0, s39, 32768
    s_add_u32 s3, s3, 0
    buffer_load_dwordx4 v8, s[28:31], s3 offen offset:0 sc1 lds
    buffer_load_dwordx4 v8, s[28:31], s3 offen offset:1024 sc1 lds
    buffer_load_dwordx4 v8, s[28:31], s3 offen offset:2048 sc1 lds
    buffer_load_dwordx4 v8, s[28:31], s3 offen offset:3072 sc1 lds
    s_add_u32 m0, s39, 36864
    s_add_u32 s3, s3, 4096
    buffer_load_dwordx4 v8, s[28:31], s3 offen offset:0 sc1 lds
    buffer_load_dwordx4 v8, s[28:31], s3 offen offset:1024 sc1 lds
    buffer_load_dwordx4 v8, s[28:31], s3 offen offset:2048 sc1 lds
    buffer_load_dwordx4 v8, s[28:31], s3 offen offset:3072 sc1 lds
    s_cmp_ge_u32 s48, 28
    s_cbranch_scc1 L_LOADER
    s_mul_i32 s56, s48, 37
    s_lshr_b32 s56, s56, 8
    s_mul_i32 s57, s56, 7
    s_sub_u32 s57, s48, s57
    s_lshl_b32 s3, s27, 2
    s_add_u32 s56, s56, s3
    s_lshl_b32 s46, s49, 14
    s_add_u32 s46, s46, 98304
    s_mul_i32 s47, s56, 224
    s_mul_i32 s3, s49, 28
    s_add_u32 s47, s47, s3
    s_lshl_b32 s47, s47, 10
    s_add_u32 s47, s47, 6291456
    s_mul_i32 s44, s49, 401408
    s_mul_i32 s45, s49, 100352
    s_add_u32 s62, s49, 4
    s_sub_u32 s3, s49, 2
    s_cmp_lt_u32 s49, 2
    s_cselect_b32 s62, s62, s3
    s_lshl_b32 s62, s62, 14
    v_lshrrev_b32 v3, 3, v1
    v_bfe_u32 v4, v1, 1, 2
    v_and_b32 v5, 2, v3
    v_xor_b32 v4, v4, v5
    v_and_b32 v5, 1, v1
    v_mul_u32_u24 v6, 896, v3
    v_lshl_add_u32 v6, v4, 5, v6
    v_lshl_add_u32 v6, v5, 4, v6
    s_lshl_b32 s3, s57, 7
    v_add_u32 v10, s3, v6
    v_lshrrev_b32 v3, 5, v1
    v_bfe_u32 v4, v1, 4, 1
    v_bfe_u32 v5, v1, 2, 2
    v_and_b32 v6, 3, v1
    v_lshl_add_u32 v7, v3, 2, v5
    v_lshlrev_b32 v7, 7, v7
    v_lshl_add_u32 v7, v6, 3, v7
    v_and_b32 v5, 2, v5
    v_xor_b32 v5, v5, v4
    v_lshl_add_u32 v6, v5, 5, v7
    v_add_u32 v11, s46, v6
    v_xor_b32 v5, 2, v5
    v_lshl_add_u32 v6, v5, 5, v7
    v_add_u32 v12, s46, v6
    v_add_u32 v13, s46, v9
    s_lshl_b32 s3, s49, 12
    s_add_u32 s3, s3, 98304
    v_add_u32 v14, s3, v9
    s_mov_b32 s32, s16
    s_and_b32 s33, s17, 0xffff
    s_mov_b32 s34, 1605632
    s_mov_b32 s35, 0x20000
    s_mov_b32 s36, 0x10985410
    s_mov_b32 s37, 0x9854
    s_mov_b32 s64, 0xba7632dc
    s_mov_b32 s59, 0x3330000
    s_bitcmp1_b32 s49, 0
    s_cselect_b32 s36, 0x32ba7632, s36
    s_cselect_b32 s37, 0xba76, s37
    s_cselect_b32 s64, 0xdc985410, s64
    s_cselect_b32 s59, 0xccc0000, s59
    s_mov_b32 s65, s64
    s_and_b32 s3, s56, 3
    s_mul_i32 s3, s3, 0
    s_mul_i32 s66, s57, 0
    s_add_u32 s3, s3, s66
    s_and_b32 s66, s3, 7
    s_lshl_b32 s66, s66, 2
    s_lshr_b64 s[64:65], s[64:65], s66
    s_mul_i32 s66, s3, 43
    s_lshr_b32 s66, s66, 8
    s_mul_i32 s66, s66, 6
    s_sub_u32 s3, s3, s66
    s_lshl_b32 s3, s3, 2
    s_lshr_b64 s[36:37], s[36:37], s3
    s_mov_b32 s37, s64
    s_mul_i32 s3, s56, 4352
    v_mov_b32 v3, s58
    v_mov_b32 v4, s3
    v_cmp_gt_u32 vcc, 4, v1
    v_and_b32 v5, 1, v1
    s_mov_b32 s61, 22368256
    v_cndmask_b32 v3, v4, v3, vcc
    v_lshl_add_u32 v3, v5, 3, v3
    v_add_u32 v163, s61, v3
    v_and_b32 v15, 15, v1
    v_min_u32 v15, 13, v15
    v_lshlrev_b32 v15, 3, v15
    s_lshl_b32 s61, s56, 2
    s_add_u32 s61, s61, s49
    s_mul_i32 s61, s61, 4352
    s_add_u32 s61, s61, 22507520
    v_add_u32 v15, s61, v15
    v_cmp_gt_u32 vcc, 16, v1
    s_nop 1
    v_cndmask_b32 v15, v15, v163, vcc
    v_and_b32 v3, 31, v1
    v_lshlrev_b32 v3, 2, v3
    s_setprio 0
    s_bfe_u32 s3, s36, 0x40000
    s_mul_i32 s3, s3, 28672
    s_add_u32 m0, s46, 0
    s_add_u32 s3, s3, s44
    buffer_load_dwordx4 v10, s[32:35], s3 offen lds
    s_add_u32 s3, s3, 6144
    buffer_load_dwordx4 v10, s[32:35], s3 offen offset:1024 lds
    s_bfe_u32 s3, s36, 0x40000
    s_mul_i32 s3, s3, 28672
    s_add_u32 m0, s46, 2048
    s_add_u32 s3, s3, s44
    s_add_u32 s3, s3, 14336
    buffer_load_dwordx4 v10, s[32:35], s3 offen lds
    s_add_u32 s3, s3, 6144
    buffer_load_dwordx4 v10, s[32:35], s3 offen offset:1024 lds
    s_bfe_u32 s3, s36, 0x40004
    s_mul_i32 s3, s3, 28672
    s_add_u32 m0, s46, 4096
    s_add_u32 s3, s3, s44
    buffer_load_dwordx4 v10, s[32:35], s3 offen lds
    s_add_u32 s3, s3, 6144
    buffer_load_dwordx4 v10, s[32:35], s3 offen offset:1024 lds
    s_bfe_u32 s3, s36, 0x40004
    s_mul_i32 s3, s3, 28672
    s_add_u32 m0, s46, 6144
    s_add_u32 s3, s3, s44
    s_add_u32 s3, s3, 14336
    buffer_load_dwordx4 v10, s[32:35], s3 offen lds
    s_add_u32 s3, s3, 6144
    buffer_load_dwordx4 v10, s[32:35], s3 offen offset:1024 lds
    s_bfe_u32 s3, s36, 0x40008
    s_mul_i32 s3, s3, 28672
    s_add_u32 m0, s46, 8192
    s_add_u32 s3, s3, s44
    buffer_load_dwordx4 v10, s[32:35], s3 offen lds
    s_add_u32 s3, s3, 6144
    buffer_load_dwordx4 v10, s[32:35], s3 offen offset:1024 lds
    s_bfe_u32 s3, s36, 0x40008
    s_mul_i32 s3, s3, 28672
    s_add_u32 m0, s46, 10240
    s_add_u32 s3, s3, s44
    s_add_u32 s3, s3, 14336
    buffer_load_dwordx4 v10, s[32:35], s3 offen lds
    s_add_u32 s3, s3, 6144
    buffer_load_dwordx4 v10, s[32:35], s3 offen offset:1024 lds
    s_bfe_u32 s3, s36, 0x4000c
    s_mul_i32 s3, s3, 28672
    s_add_u32 m0, s46, 12288
    s_add_u32 s3, s3, s44
    buffer_load_dwordx4 v10, s[32:35], s3 offen lds
    s_add_u32 s3, s3, 6144
    buffer_load_dwordx4 v10, s[32:35], s3 offen offset:1024 lds
    s_bfe_u32 s3, s36, 0x4000c
    s_mul_i32 s3, s3, 28672
    s_add_u32 m0, s46, 14336
    s_add_u32 s3, s3, s44
    s_add_u32 s3, s3, 14336
    buffer_load_dwordx4 v10, s[32:35], s3 offen lds
    s_add_u32 s3, s3, 6144
    buffer_load_dwordx4 v10, s[32:35], s3 offen offset:1024 lds
    s_lshl_b32 s64, s56, 6
    s_lshl_b32 s3, s49, 3
    s_add_u32 s64, s64, s3
    s_lshl_b32 s64, s64, 10
    s_add_u32 s64, s64, 14680064
    s_add_u32 s65, s64, 32768
    s_add_u32 s66, s64, 4096
    s_add_u32 s67, s65, 4096
    s_setprio 3
    v_and_b32 v2, 2, v1
    v_cmp_eq_u32 vcc, 0, v2
    v_and_b32 v2, 1, v1
    v_lshlrev_b32 v2, 4, v2
    v_cndmask_b32 v161, v165, v164, vcc
    v_lshlrev_b32 v161, v2, v161
    v_and_b32 v161, 0xffff0000, v161
    v_lshrrev_b32 v2, 5, v1
    v_mul_u32_u24 v2, 4, v2
    v_bfe_u32 v6, v1, 2, 2
    v_add3_u32 v2, v2, v6, 0
    v_bfe_u32 v6, v1, 4, 1
    v_and_b32 v163, 2, v2
    v_xor_b32 v6, v6, v163
    v_lshlrev_b32 v2, 7, v2
    v_lshl_add_u32 v2, v6, 5, v2
    v_and_b32 v6, 3, v1
    v_lshl_add_u32 v2, v6, 3, v2
    v_add_u32 v2, s62, v2
    v_lshrrev_b32 v4, 5, v1
    v_mul_u32_u24 v4, 3, v4
    v_bfe_u32 v6, v1, 2, 2
    v_add3_u32 v4, v4, v6, 8
    v_bfe_u32 v6, v1, 4, 1
    v_and_b32 v163, 2, v4
    v_xor_b32 v6, v6, v163
    v_lshlrev_b32 v4, 7, v4
    v_lshl_add_u32 v4, v6, 5, v4
    v_and_b32 v6, 3, v1
    v_lshl_add_u32 v4, v6, 3, v4
    v_add_u32 v4, s62, v4
    v_lshrrev_b32 v5, 5, v1
    v_mul_u32_u24 v5, 4, v5
    v_bfe_u32 v6, v1, 2, 2
    v_add3_u32 v5, v5, v6, 14
    v_bfe_u32 v6, v1, 4, 1
    v_and_b32 v163, 2, v5
    v_xor_b32 v6, v6, v163
    v_lshlrev_b32 v5, 7, v5
    v_lshl_add_u32 v5, v6, 5, v5
    v_and_b32 v6, 3, v1
    v_lshl_add_u32 v5, v6, 3, v5
    v_add_u32 v5, s62, v5
    v_lshrrev_b32 v160, 5, v1
    v_mul_u32_u24 v160, 3, v160
    v_bfe_u32 v6, v1, 2, 2
    v_add3_u32 v160, v160, v6, 22
    v_bfe_u32 v6, v1, 4, 1
    v_and_b32 v163, 2, v160
    v_xor_b32 v6, v6, v163
    v_lshlrev_b32 v160, 7, v160
    v_lshl_add_u32 v160, v6, 5, v160
    v_and_b32 v6, 3, v1
    v_lshl_add_u32 v160, v6, 3, v160
    v_add_u32 v160, s62, v160
    v_and_b32 v163, 31, v1
    s_lshr_b32 s61, s49, 1
    s_lshl_b32 s3, s56, 1
    s_add_u32 s3, s3, s61
    s_lshl_b32 s3, s3, 5
    v_add_u32 v163, s3, v163
    v_mul_u32_u24 v162, 896, v163
    v_lshrrev_b32 v163, 5, v1
    v_lshl_add_u32 v162, v163, 4, v162
    s_lshl_b32 s63, s57, 7
    s_and_b32 s3, s49, 1
    s_lshl_b32 s3, s3, 6
    s_add_u32 s63, s63, s3
    s_setprio 0
    s_waitcnt vmcnt(16)
    s_barrier
    s_mov_b32 s3, 2
    s_and_b32 s3, s3, 7
    s_lshl_b32 s3, s3, 15
    s_add_u32 s3, s3, s38
    s_add_u32 m0, s39, 65536
    s_add_u32 s3, s3, 0
    buffer_load_dwordx4 v8, s[28:31], s3 offen offset:0 sc1 lds
    buffer_load_dwordx4 v8, s[28:31], s3 offen offset:1024 sc1 lds
    buffer_load_dwordx4 v8, s[28:31], s3 offen offset:2048 sc1 lds
    buffer_load_dwordx4 v8, s[28:31], s3 offen offset:3072 sc1 lds
    s_add_u32 m0, s39, 69632
    s_add_u32 s3, s3, 4096
    buffer_load_dwordx4 v8, s[28:31], s3 offen offset:0 sc1 lds
    buffer_load_dwordx4 v8, s[28:31], s3 offen offset:1024 sc1 lds
    buffer_load_dwordx4 v8, s[28:31], s3 offen offset:2048 sc1 lds
    buffer_load_dwordx4 v8, s[28:31], s3 offen offset:3072 sc1 lds
    s_mov_b32 s3, 3
    s_and_b32 s3, s3, 7
    s_lshl_b32 s3, s3, 15
    s_add_u32 s3, s3, s38
    s_add_u32 m0, s39, 0
    s_add_u32 s3, s3, 0
    buffer_load_dwordx4 v8, s[28:31], s3 offen offset:0 sc1 lds
    buffer_load_dwordx4 v8, s[28:31], s3 offen offset:1024 sc1 lds
    buffer_load_dwordx4 v8, s[28:31], s3 offen offset:2048 sc1 lds
    buffer_load_dwordx4 v8, s[28:31], s3 offen offset:3072 sc1 lds
    s_add_u32 m0, s39, 4096
    s_add_u32 s3, s3, 4096
    buffer_load_dwordx4 v8, s[28:31], s3 offen offset:0 sc1 lds
    buffer_load_dwordx4 v8, s[28:31], s3 offen offset:1024 sc1 lds
    buffer_load_dwordx4 v8, s[28:31], s3 offen offset:2048 sc1 lds
    buffer_load_dwordx4 v8, s[28:31], s3 offen offset:3072 sc1 lds
    s_waitcnt vmcnt(8)
    buffer_load_dwordx2 v[6:7], v15, s[28:31], s52 offen sc1
    s_barrier
    s_setprio 3
    s_mov_b32 s69, 0x40000
HP_6:
    s_waitcnt vmcnt(0)
    v_cmp_eq_u64 vcc, s[50:51], v[6:7]
    s_sub_u32 s69, s69, 1
    s_cbranch_scc1 L_HOK
    s_andn2_b32 s3, s59, vcc_lo
    s_cbranch_scc0 L_HOK
    buffer_load_dwordx2 v[6:7], v15, s[28:31], s52 offen sc1
    s_branch HP_6
L_HOK:
    s_setprio 0
    s_mov_b32 s3, 4
    s_and_b32 s3, s3, 7
    s_lshl_b32 s3, s3, 15
    s_add_u32 s3, s3, s38
    s_add_u32 m0, s39, 32768
    s_add_u32 s3, s3, 0
    buffer_load_dwordx4 v8, s[28:31], s3 offen offset:0 sc1 lds
    buffer_load_dwordx4 v8, s[28:31], s3 offen offset:1024 sc1 lds
    buffer_load_dwordx4 v8, s[28:31], s3 offen offset:2048 sc1 lds
    buffer_load_dwordx4 v8, s[28:31], s3 offen offset:3072 sc1 lds
    s_add_u32 m0, s39, 36864
    s_add_u32 s3, s3, 4096
    buffer_load_dwordx4 v8, s[28:31], s3 offen offset:0 sc1 lds
    buffer_load_dwordx4 v8, s[28:31], s3 offen offset:1024 sc1 lds
    buffer_load_dwordx4 v8, s[28:31], s3 offen offset:2048 sc1 lds
    buffer_load_dwordx4 v8, s[28:31], s3 offen offset:3072 sc1 lds
    s_bfe_u32 s3, s36, 0x40000
    s_lshl_b32 s3, s3, 11
    s_add_u32 s3, s3, s47
    buffer_load_dwordx4 v[80:83], v9, s[28:31], s3 offen offset:0 sc1
    s_bfe_u32 s3, s36, 0x40000
    s_lshl_b32 s3, s3, 11
    s_add_u32 s3, s3, s47
    s_add_u32 s3, s3, 114688
    buffer_load_dwordx4 v[84:87], v9, s[28:31], s3 offen offset:0 sc1
    s_bfe_u32 s3, s36, 0x40000
    s_lshl_b32 s3, s3, 11
    s_add_u32 s3, s3, s47
    buffer_load_dwordx4 v[88:91], v9, s[28:31], s3 offen offset:1024 sc1
    s_bfe_u32 s3, s36, 0x40000
    s_lshl_b32 s3, s3, 11
    s_add_u32 s3, s3, s47
    s_add_u32 s3, s3, 114688
    buffer_load_dwordx4 v[92:95], v9, s[28:31], s3 offen offset:1024 sc1
    s_bfe_u32 s3, s36, 0x40004
    s_lshl_b32 s3, s3, 11
    s_add_u32 s3, s3, s47
    buffer_load_dwordx4 v[96:99], v9, s[28:31], s3 offen offset:0 sc1
    s_bfe_u32 s3, s36, 0x40004
    s_lshl_b32 s3, s3, 11
    s_add_u32 s3, s3, s47
    s_add_u32 s3, s3, 114688
    buffer_load_dwordx4 v[100:103], v9, s[28:31], s3 offen offset:0 sc1
    s_bfe_u32 s3, s36, 0x40004
    s_lshl_b32 s3, s3, 11
    s_add_u32 s3, s3, s47
    buffer_load_dwordx4 v[104:107], v9, s[28:31], s3 offen offset:1024 sc1
    s_bfe_u32 s3, s36, 0x40004
    s_lshl_b32 s3, s3, 11
    s_add_u32 s3, s3, s47
    s_add_u32 s3, s3, 114688
    buffer_load_dwordx4 v[108:111], v9, s[28:31], s3 offen offset:1024 sc1
    ds_read_b64_tr_b16 v[144:145], v11 offset:0
    ds_read_b64_tr_b16 v[146:147], v11 offset:1024
    ds_read_b64_tr_b16 v[148:149], v12 offset:0
    ds_read_b64_tr_b16 v[150:151], v12 offset:1024
    s_barrier
    s_mov_b32 s3, 5
    s_and_b32 s3, s3, 7
    s_lshl_b32 s3, s3, 15
    s_add_u32 s3, s3, s38
    s_add_u32 m0, s39, 65536
    s_add_u32 s3, s3, 0
    buffer_load_dwordx4 v8, s[28:31], s3 offen offset:0 sc1 lds
    buffer_load_dwordx4 v8, s[28:31], s3 offen offset:1024 sc1 lds
    buffer_load_dwordx4 v8, s[28:31], s3 offen offset:2048 sc1 lds
    buffer_load_dwordx4 v8, s[28:31], s3 offen offset:3072 sc1 lds
    s_add_u32 m0, s39, 69632
    s_add_u32 s3, s3, 4096
    buffer_load_dwordx4 v8, s[28:31], s3 offen offset:0 sc1 lds
    buffer_load_dwordx4 v8, s[28:31], s3 offen offset:1024 sc1 lds
    buffer_load_dwordx4 v8, s[28:31], s3 offen offset:2048 sc1 lds
    buffer_load_dwordx4 v8, s[28:31], s3 offen offset:3072 sc1 lds
    s_waitcnt vmcnt(14)
    s_waitcnt lgkmcnt(0)
    ds_read_b64_tr_b16 v[152:153], v11 offset:2048
    ds_read_b64_tr_b16 v[154:155], v11 offset:3072
    ds_read_b64_tr_b16 v[156:157], v12 offset:2048
    ds_read_b64_tr_b16 v[158:159], v12 offset:3072
    v_mfma_f32_32x32x16_bf16 v[16:31], v[144:147], v[80:83], 0
    s_bfe_u32 s3, s36, 0x40008
    s_lshl_b32 s3, s3, 11
    s_add_u32 s3, s3, s47
    buffer_load_dwordx4 v[112:115], v9, s[28:31], s3 offen offset:0 sc1
    s_bfe_u32 s3, s36, 0x40010
    s_mul_i32 s3, s3, 28672
    s_add_u32 m0, s46, 0
    s_add_u32 s3, s3, s44
    buffer_load_dwordx4 v10, s[32:35], s3 offen lds
    s_add_u32 s3, s3, 6144
    buffer_load_dwordx4 v10, s[32:35], s3 offen offset:1024 lds
    v_mfma_f32_32x32x16_bf16 v[32:47], v[148:151], v[80:83], 0
    s_bfe_u32 s3, s36, 0x40010
    s_lshl_b32 s3, s3, 11
    s_add_u32 s3, s3, s47
    buffer_load_dwordx4 v[80:83], v9, s[28:31], s3 offen offset:0 sc1
    v_mfma_f32_32x32x16_bf16 v[48:63], v[144:147], v[84:87], 0
    s_bfe_u32 s3, s36, 0x40008
    s_lshl_b32 s3, s3, 11
    s_add_u32 s3, s3, s47
    s_add_u32 s3, s3, 114688
    buffer_load_dwordx4 v[116:119], v9, s[28:31], s3 offen offset:0 sc1
    v_mfma_f32_32x32x16_bf16 v[64:79], v[148:151], v[84:87], 0
    s_bfe_u32 s3, s36, 0x40010
    s_lshl_b32 s3, s3, 11
    s_add_u32 s3, s3, s47
    s_add_u32 s3, s3, 114688
    buffer_load_dwordx4 v[84:87], v9, s[28:31], s3 offen offset:0 sc1
    s_waitcnt vmcnt(18)
    s_waitcnt lgkmcnt(0)
    ds_read_b64_tr_b16 v[144:145], v11 offset:4096
    ds_read_b64_tr_b16 v[146:147], v11 offset:5120
    ds_read_b64_tr_b16 v[148:149], v12 offset:4096
    ds_read_b64_tr_b16 v[150:151], v12 offset:5120
    v_mfma_f32_32x32x16_bf16 v[16:31], v[152:155], v[88:91], v[16:31]
    s_bfe_u32 s3, s36, 0x40008
    s_lshl_b32 s3, s3, 11
    s_add_u32 s3, s3, s47
    buffer_load_dwordx4 v[120:123], v9, s[28:31], s3 offen offset:1024 sc1
    s_bfe_u32 s3, s36, 0x40010
    s_mul_i32 s3, s3, 28672
    s_add_u32 m0, s46, 2048
    s_add_u32 s3, s3, s44
    s_add_u32 s3, s3, 14336
    buffer_load_dwordx4 v10, s[32:35], s3 offen lds
    s_add_u32 s3, s3, 6144
    buffer_load_dwordx4 v10, s[32:35], s3 offen offset:1024 lds
    v_mfma_f32_32x32x16_bf16 v[32:47], v[156:159], v[88:91], v[32:47]
    s_bfe_u32 s3, s36, 0x40010
    s_lshl_b32 s3, s3, 11
    s_add_u32 s3, s3, s47
    buffer_load_dwordx4 v[88:91], v9, s[28:31], s3 offen offset:1024 sc1
    v_mfma_f32_32x32x16_bf16 v[48:63], v[152:155], v[92:95], v[48:63]
    s_bfe_u32 s3, s36, 0x40008
    s_lshl_b32 s3, s3, 11
    s_add_u32 s3, s3, s47
    s_add_u32 s3, s3, 114688
    buffer_load_dwordx4 v[124:127], v9, s[28:31], s3 offen offset:1024 sc1
    v_mfma_f32_32x32x16_bf16 v[64:79], v[156:159], v[92:95], v[64:79]
    s_bfe_u32 s3, s36, 0x40010
    s_lshl_b32 s3, s3, 11
    s_add_u32 s3, s3, s47
    s_add_u32 s3, s3, 114688
    buffer_load_dwordx4 v[92:95], v9, s[28:31], s3 offen offset:1024 sc1
    s_waitcnt vmcnt(22)
    s_waitcnt lgkmcnt(0)
    ds_read_b64_tr_b16 v[152:153], v11 offset:6144
    ds_read_b64_tr_b16 v[154:155], v11 offset:7168
    ds_read_b64_tr_b16 v[156:157], v12 offset:6144
    ds_read_b64_tr_b16 v[158:159], v12 offset:7168
    v_mfma_f32_32x32x16_bf16 v[16:31], v[144:147], v[96:99], v[16:31]
    s_bfe_u32 s3, s36, 0x4000c
    s_lshl_b32 s3, s3, 11
    s_add_u32 s3, s3, s47
    buffer_load_dwordx4 v[128:131], v9, s[28:31], s3 offen offset:0 sc1
    s_bfe_u32 s3, s36, 0x40014
    s_mul_i32 s3, s3, 28672
    s_add_u32 m0, s46, 4096
    s_add_u32 s3, s3, s44
    buffer_load_dwordx4 v10, s[32:35], s3 offen lds
    s_add_u32 s3, s3, 6144
    buffer_load_dwordx4 v10, s[32:35], s3 offen offset:1024 lds
    v_mfma_f32_32x32x16_bf16 v[32:47], v[148:151], v[96:99], v[32:47]
    s_bfe_u32 s3, s36, 0x40014
    s_lshl_b32 s3, s3, 11
    s_add_u32 s3, s3, s47
    buffer_load_dwordx4 v[96:99], v9, s[28:31], s3 offen offset:0 sc1
    v_mfma_f32_32x32x16_bf16 v[48:63], v[144:147], v[100:103], v[48:63]
    s_bfe_u32 s3, s36, 0x4000c
    s_lshl_b32 s3, s3, 11
    s_add_u32 s3, s3, s47
    s_add_u32 s3, s3, 114688
    buffer_load_dwordx4 v[132:135], v9, s[28:31], s3 offen offset:0 sc1
    v_mfma_f32_32x32x16_bf16 v[64:79], v[148:151], v[100:103], v[64:79]
    s_bfe_u32 s3, s36, 0x40014
    s_lshl_b32 s3, s3, 11
    s_add_u32 s3, s3, s47
    s_add_u32 s3, s3, 114688
    buffer_load_dwordx4 v[100:103], v9, s[28:31], s3 offen offset:0 sc1
    buffer_load_dwordx2 v[6:7], v15, s[28:31], s52 offen sc1
    s_barrier
    s_setprio 3
    s_waitcnt vmcnt(0)
    v_cmp_eq_u64 vcc, s[50:51], v[6:7]
    s_nop 1
    s_cmp_eq_u64 vcc, -1
    s_cbranch_scc1 L_HOK2
    s_mov_b32 s69, 0x40000
POLL_7:
    buffer_load_dwordx2 v[6:7], v15, s[28:31], s52 offen sc1
    s_waitcnt vmcnt(0)
    v_cmp_eq_u64 vcc, s[50:51], v[6:7]
    s_sub_u32 s69, s69, 1
    s_cbranch_scc1 POLLD_8
    s_cmp_eq_u64 vcc, -1
    s_cbranch_scc1 POLLD_8
    s_sleep 4
    s_branch POLL_7
POLLD_8:
L_HOK2:
    s_setprio 0
    s_mov_b32 s3, 6
    s_and_b32 s3, s3, 7
    s_lshl_b32 s3, s3, 15
    s_add_u32 s3, s3, s38
    s_add_u32 m0, s39, 0
    s_add_u32 s3, s3, 0
    buffer_load_dwordx4 v8, s[28:31], s3 offen offset:0 sc1 lds
    buffer_load_dwordx4 v8, s[28:31], s3 offen offset:1024 sc1 lds
    buffer_load_dwordx4 v8, s[28:31], s3 offen offset:2048 sc1 lds
    buffer_load_dwordx4 v8, s[28:31], s3 offen offset:3072 sc1 lds
    s_add_u32 m0, s39, 4096
    s_add_u32 s3, s3, 4096
    buffer_load_dwordx4 v8, s[28:31], s3 offen offset:0 sc1 lds
    buffer_load_dwordx4 v8, s[28:31], s3 offen offset:1024 sc1 lds
    buffer_load_dwordx4 v8, s[28:31], s3 offen offset:2048 sc1 lds
    buffer_load_dwordx4 v8, s[28:31], s3 offen offset:3072 sc1 lds
    s_waitcnt lgkmcnt(0)
    ds_read_b64_tr_b16 v[144:145], v11 offset:8192
    ds_read_b64_tr_b16 v[146:147], v11 offset:9216
    ds_read_b64_tr_b16 v[148:149], v12 offset:8192
    ds_read_b64_tr_b16 v[150:151], v12 offset:9216
    v_mfma_f32_32x32x16_bf16 v[16:31], v[152:155], v[104:107], v[16:31]
    s_bfe_u32 s3, s36, 0x4000c
    s_lshl_b32 s3, s3, 11
    s_add_u32 s3, s3, s47
    buffer_load_dwordx4 v[136:139], v9, s[28:31], s3 offen offset:1024 sc1
    s_bfe_u32 s3, s36, 0x40014
    s_mul_i32 s3, s3, 28672
    s_add_u32 m0, s46, 6144
    s_add_u32 s3, s3, s44
    s_add_u32 s3, s3, 14336
    buffer_load_dwordx4 v10, s[32:35], s3 offen lds
    s_add_u32 s3, s3, 6144
    buffer_load_dwordx4 v10, s[32:35], s3 offen offset:1024 lds
    v_mfma_f32_32x32x16_bf16 v[32:47], v[156:159], v[104:107], v[32:47]
    s_bfe_u32 s3, s36, 0x40014
    s_lshl_b32 s3, s3, 11
    s_add_u32 s3, s3, s47
    buffer_load_dwordx4 v[104:107], v9, s[28:31], s3 offen offset:1024 sc1
    v_mfma_f32_32x32x16_bf16 v[48:63], v[152:155], v[108:111], v[48:63]
    s_bfe_u32 s3, s36, 0x4000c
    s_lshl_b32 s3, s3, 11
    s_add_u32 s3, s3, s47
    s_add_u32 s3, s3, 114688
    buffer_load_dwordx4 v[140:143], v9, s[28:31], s3 offen offset:1024 sc1
    v_mfma_f32_32x32x16_bf16 v[64:79], v[156:159], v[108:111], v[64:79]
    s_bfe_u32 s3, s36, 0x40014
    s_lshl_b32 s3, s3, 11
    s_add_u32 s3, s3, s47
    s_add_u32 s3, s3, 114688
    buffer_load_dwordx4 v[108:111], v9, s[28:31], s3 offen offset:1024 sc1
    s_waitcnt lgkmcnt(0)
    ds_read_b64_tr_b16 v[152:153], v11 offset:10240
    ds_read_b64_tr_b16 v[154:155], v11 offset:11264
    ds_read_b64_tr_b16 v[156:157], v12 offset:10240
    ds_read_b64_tr_b16 v[158:159], v12 offset:11264
    v_mfma_f32_32x32x16_bf16 v[16:31], v[144:147], v[112:115], v[16:31]
    s_bfe_u32 s3, s37, 0x40000
    s_mul_i32 s3, s3, 28672
    s_add_u32 m0, s46, 8192
    s_add_u32 s3, s3, s44
    buffer_load_dwordx4 v10, s[32:35], s3 offen lds
    s_add_u32 s3, s3, 6144
    buffer_load_dwordx4 v10, s[32:35], s3 offen offset:1024 lds
    v_mfma_f32_32x32x16_bf16 v[32:47], v[148:151], v[112:115], v[32:47]
    s_bfe_u32 s3, s37, 0x40000
    s_lshl_b32 s3, s3, 11
    s_add_u32 s3, s3, s47
    buffer_load_dwordx4 v[112:115], v9, s[28:31], s3 offen offset:0 sc1
    v_mfma_f32_32x32x16_bf16 v[48:63], v[144:147], v[116:119], v[48:63]
    v_mfma_f32_32x32x16_bf16 v[64:79], v[148:151], v[116:119], v[64:79]
    s_bfe_u32 s3, s37, 0x40000
    s_lshl_b32 s3, s3, 11
    s_add_u32 s3, s3, s47
    s_add_u32 s3, s3, 114688
    buffer_load_dwordx4 v[116:119], v9, s[28:31], s3 offen offset:0 sc1
    s_waitcnt lgkmcnt(0)
    ds_read_b64_tr_b16 v[144:145], v11 offset:12288
    ds_read_b64_tr_b16 v[146:147], v11 offset:13312
    ds_read_b64_tr_b16 v[148:149], v12 offset:12288
    ds_read_b64_tr_b16 v[150:151], v12 offset:13312
    v_mfma_f32_32x32x16_bf16 v[16:31], v[152:155], v[120:123], v[16:31]
    s_bfe_u32 s3, s37, 0x40000
    s_mul_i32 s3, s3, 28672
    s_add_u32 m0, s46, 10240
    s_add_u32 s3, s3, s44
    s_add_u32 s3, s3, 14336
    buffer_load_dwordx4 v10, s[32:35], s3 offen lds
    s_add_u32 s3, s3, 6144
    buffer_load_dwordx4 v10, s[32:35], s3 offen offset:1024 lds
    v_mfma_f32_32x32x16_bf16 v[32:47], v[156:159], v[120:123], v[32:47]
    s_bfe_u32 s3, s37, 0x40000
    s_lshl_b32 s3, s3, 11
    s_add_u32 s3, s3, s47
    buffer_load_dwordx4 v[120:123], v9, s[28:31], s3 offen offset:1024 sc1
    v_mfma_f32_32x32x16_bf16 v[48:63], v[152:155], v[124:127], v[48:63]
    v_mfma_f32_32x32x16_bf16 v[64:79], v[156:159], v[124:127], v[64:79]
    s_bfe_u32 s3, s37, 0x40000
    s_lshl_b32 s3, s3, 11
    s_add_u32 s3, s3, s47
    s_add_u32 s3, s3, 114688
    buffer_load_dwordx4 v[124:127], v9, s[28:31], s3 offen offset:1024 sc1
    s_barrier
    s_mov_b32 s3, 7
    s_and_b32 s3, s3, 7
    s_lshl_b32 s3, s3, 15
    s_add_u32 s3, s3, s38
    s_add_u32 m0, s39, 32768
    s_add_u32 s3, s3, 0
    buffer_load_dwordx4 v8, s[28:31], s3 offen offset:0 sc1 lds
    buffer_load_dwordx4 v8, s[28:31], s3 offen offset:1024 sc1 lds
    buffer_load_dwordx4 v8, s[28:31], s3 offen offset:2048 sc1 lds
    buffer_load_dwordx4 v8, s[28:31], s3 offen offset:3072 sc1 lds
    s_add_u32 m0, s39, 36864
    s_add_u32 s3, s3, 4096
    buffer_load_dwordx4 v8, s[28:31], s3 offen offset:0 sc1 lds
    buffer_load_dwordx4 v8, s[28:31], s3 offen offset:1024 sc1 lds
    buffer_load_dwordx4 v8, s[28:31], s3 offen offset:2048 sc1 lds
    buffer_load_dwordx4 v8, s[28:31], s3 offen offset:3072 sc1 lds
    s_waitcnt lgkmcnt(0)
    ds_read_b64_tr_b16 v[152:153], v11 offset:14336
    ds_read_b64_tr_b16 v[154:155], v11 offset:15360
    ds_read_b64_tr_b16 v[156:157], v12 offset:14336
    ds_read_b64_tr_b16 v[158:159], v12 offset:15360
    v_mfma_f32_32x32x16_bf16 v[16:31], v[144:147], v[128:131], v[16:31]
    s_bfe_u32 s3, s37, 0x40004
    s_mul_i32 s3, s3, 28672
    s_add_u32 m0, s46, 12288
    s_add_u32 s3, s3, s44
    buffer_load_dwordx4 v10, s[32:35], s3 offen lds
    s_add_u32 s3, s3, 6144
    buffer_load_dwordx4 v10, s[32:35], s3 offen offset:1024 lds
    v_mfma_f32_32x32x16_bf16 v[32:47], v[148:151], v[128:131], v[32:47]
    s_bfe_u32 s3, s37, 0x40004
    s_lshl_b32 s3, s3, 11
    s_add_u32 s3, s3, s47
    buffer_load_dwordx4 v[128:131], v9, s[28:31], s3 offen offset:0 sc1
    v_mfma_f32_32x32x16_bf16 v[48:63], v[144:147], v[132:135], v[48:63]
    v_mfma_f32_32x32x16_bf16 v[64:79], v[148:151], v[132:135], v[64:79]
    s_bfe_u32 s3, s37, 0x40004
    s_lshl_b32 s3, s3, 11
    s_add_u32 s3, s3, s47
    s_add_u32 s3, s3, 114688
    buffer_load_dwordx4 v[132:135], v9, s[28:31], s3 offen offset:0 sc1
    s_waitcnt vmcnt(21)
    s_waitcnt lgkmcnt(0)
    ds_read_b64_tr_b16 v[144:145], v11 offset:0
    ds_read_b64_tr_b16 v[146:147], v11 offset:1024
    ds_read_b64_tr_b16 v[148:149], v12 offset:0
    ds_read_b64_tr_b16 v[150:151], v12 offset:1024
    v_mfma_f32_32x32x16_bf16 v[16:31], v[152:155], v[136:139], v[16:31]
    s_bfe_u32 s3, s37, 0x40004
    s_mul_i32 s3, s3, 28672
    s_add_u32 m0, s46, 14336
    s_add_u32 s3, s3, s44
    s_add_u32 s3, s3, 14336
    buffer_load_dwordx4 v10, s[32:35], s3 offen lds
    s_add_u32 s3, s3, 6144
    buffer_load_dwordx4 v10, s[32:35], s3 offen offset:1024 lds
    v_mfma_f32_32x32x16_bf16 v[32:47], v[156:159], v[136:139], v[32:47]
    s_bfe_u32 s3, s37, 0x40004
    s_lshl_b32 s3, s3, 11
    s_add_u32 s3, s3, s47
    buffer_load_dwordx4 v[136:139], v9, s[28:31], s3 offen offset:1024 sc1
    v_mfma_f32_32x32x16_bf16 v[48:63], v[152:155], v[140:143], v[48:63]
    v_mfma_f32_32x32x16_bf16 v[64:79], v[156:159], v[140:143], v[64:79]
    s_bfe_u32 s3, s37, 0x40004
    s_lshl_b32 s3, s3, 11
    s_add_u32 s3, s3, s47
    s_add_u32 s3, s3, 114688
    buffer_load_dwordx4 v[140:143], v9, s[28:31], s3 offen offset:1024 sc1
    s_waitcnt lgkmcnt(0)
    ds_read_b64_tr_b16 v[152:153], v11 offset:2048
    ds_read_b64_tr_b16 v[154:155], v11 offset:3072
    ds_read_b64_tr_b16 v[156:157], v12 offset:2048
    ds_read_b64_tr_b16 v[158:159], v12 offset:3072
    v_mfma_f32_32x32x16_bf16 v[16:31], v[144:147], v[80:83], v[16:31]
    s_bfe_u32 s3, s37, 0x40008
    s_mul_i32 s3, s3, 28672
    s_add_u32 m0, s46, 0
    s_add_u32 s3, s3, s44
    buffer_load_dwordx4 v10, s[32:35], s3 offen lds
    s_add_u32 s3, s3, 6144
    buffer_load_dwordx4 v10, s[32:35], s3 offen offset:1024 lds
    v_mfma_f32_32x32x16_bf16 v[32:47], v[148:151], v[80:83], v[32:47]
    s_bfe_u32 s3, s37, 0x40008
    s_lshl_b32 s3, s3, 11
    s_add_u32 s3, s3, s47
    buffer_load_dwordx4 v[80:83], v9, s[28:31], s3 offen offset:0 sc1
    v_mfma_f32_32x32x16_bf16 v[48:63], v[144:147], v[84:87], v[48:63]
    v_mfma_f32_32x32x16_bf16 v[64:79], v[148:151], v[84:87], v[64:79]
    s_bfe_u32 s3, s37, 0x40008
    s_lshl_b32 s3, s3, 11
    s_add_u32 s3, s3, s47
    s_add_u32 s3, s3, 114688
    buffer_load_dwordx4 v[84:87], v9, s[28:31], s3 offen offset:0 sc1
    s_barrier
    s_waitcnt lgkmcnt(0)
    ds_read_b64_tr_b16 v[144:145], v11 offset:4096
    ds_read_b64_tr_b16 v[146:147], v11 offset:5120
    ds_read_b64_tr_b16 v[148:149], v12 offset:4096
    ds_read_b64_tr_b16 v[150:151], v12 offset:5120
    v_mfma_f32_32x32x16_bf16 v[16:31], v[152:155], v[88:91], v[16:31]
    s_bfe_u32 s3, s37, 0x40008
    s_mul_i32 s3, s3, 28672
    s_add_u32 m0, s46, 2048
    s_add_u32 s3, s3, s44
    s_add_u32 s3, s3, 14336
    buffer_load_dwordx4 v10, s[32:35], s3 offen lds
    s_add_u32 s3, s3, 6144
    buffer_load_dwordx4 v10, s[32:35], s3 offen offset:1024 lds
    v_mfma_f32_32x32x16_bf16 v[32:47], v[156:159], v[88:91], v[32:47]
    s_bfe_u32 s3, s37, 0x40008
    s_lshl_b32 s3, s3, 11
    s_add_u32 s3, s3, s47
    buffer_load_dwordx4 v[88:91], v9, s[28:31], s3 offen offset:1024 sc1
    v_mfma_f32_32x32x16_bf16 v[48:63], v[152:155], v[92:95], v[48:63]
    v_mfma_f32_32x32x16_bf16 v[64:79], v[156:159], v[92:95], v[64:79]
    s_bfe_u32 s3, s37, 0x40008
    s_lshl_b32 s3, s3, 11
    s_add_u32 s3, s3, s47
    s_add_u32 s3, s3, 114688
    buffer_load_dwordx4 v[92:95], v9, s[28:31], s3 offen offset:1024 sc1
    s_waitcnt lgkmcnt(0)
    ds_read_b64_tr_b16 v[152:153], v11 offset:6144
    ds_read_b64_tr_b16 v[154:155], v11 offset:7168
    ds_read_b64_tr_b16 v[156:157], v12 offset:6144
    ds_read_b64_tr_b16 v[158:159], v12 offset:7168
    v_mfma_f32_32x32x16_bf16 v[16:31], v[144:147], v[96:99], v[16:31]
    s_bfe_u32 s3, s37, 0x4000c
    s_mul_i32 s3, s3, 28672
    s_add_u32 m0, s46, 4096
    s_add_u32 s3, s3, s44
    buffer_load_dwordx4 v10, s[32:35], s3 offen lds
    s_add_u32 s3, s3, 6144
    buffer_load_dwordx4 v10, s[32:35], s3 offen offset:1024 lds
    v_mfma_f32_32x32x16_bf16 v[32:47], v[148:151], v[96:99], v[32:47]
    s_bfe_u32 s3, s37, 0x4000c
    s_lshl_b32 s3, s3, 11
    s_add_u32 s3, s3, s47
    buffer_load_dwordx4 v[96:99], v9, s[28:31], s3 offen offset:0 sc1
    v_mfma_f32_32x32x16_bf16 v[48:63], v[144:147], v[100:103], v[48:63]
    v_mfma_f32_32x32x16_bf16 v[64:79], v[148:151], v[100:103], v[64:79]
    s_bfe_u32 s3, s37, 0x4000c
    s_lshl_b32 s3, s3, 11
    s_add_u32 s3, s3, s47
    s_add_u32 s3, s3, 114688
    buffer_load_dwordx4 v[100:103], v9, s[28:31], s3 offen offset:0 sc1
    s_waitcnt vmcnt(34)
    s_waitcnt lgkmcnt(0)
    ds_read_b64_tr_b16 v[144:145], v11 offset:8192
    ds_read_b64_tr_b16 v[146:147], v11 offset:9216
    ds_read_b64_tr_b16 v[148:149], v12 offset:8192
    ds_read_b64_tr_b16 v[150:151], v12 offset:9216
    v_mfma_f32_32x32x16_bf16 v[16:31], v[152:155], v[104:107], v[16:31]
    s_bfe_u32 s3, s37, 0x4000c
    s_mul_i32 s3, s3, 28672
    s_add_u32 m0, s46, 6144
    s_add_u32 s3, s3, s44
    s_add_u32 s3, s3, 14336
    buffer_load_dwordx4 v10, s[32:35], s3 offen lds
    s_add_u32 s3, s3, 6144
    buffer_load_dwordx4 v10, s[32:35], s3 offen offset:1024 lds
    v_mfma_f32_32x32x16_bf16 v[32:47], v[156:159], v[104:107], v[32:47]
    s_bfe_u32 s3, s37, 0x4000c
    s_lshl_b32 s3, s3, 11
    s_add_u32 s3, s3, s47
    buffer_load_dwordx4 v[104:107], v9, s[28:31], s3 offen offset:1024 sc1
    v_mfma_f32_32x32x16_bf16 v[48:63], v[152:155], v[108:111], v[48:63]
    v_mfma_f32_32x32x16_bf16 v[64:79], v[156:159], v[108:111], v[64:79]
    s_bfe_u32 s3, s37, 0x4000c
    s_lshl_b32 s3, s3, 11
    s_add_u32 s3, s3, s47
    s_add_u32 s3, s3, 114688
    buffer_load_dwordx4 v[108:111], v9, s[28:31], s3 offen offset:1024 sc1
    s_waitcnt vmcnt(24)
    s_barrier
    s_mov_b32 s40, s8
    s_and_b32 s41, s9, 0xffff
    s_mov_b32 s42, 401408
    s_mov_b32 s43, 0x20000
    s_add_u32 m0, s62, 0
    s_add_u32 s3, s45, 0
    buffer_load_dwordx4 v10, s[40:43], s3 offen offset:0 lds
    s_add_u32 s3, s45, 6144
    buffer_load_dwordx4 v10, s[40:43], s3 offen offset:1024 lds
    s_add_u32 s3, s45, 12288
    buffer_load_dwordx4 v10, s[40:43], s3 offen offset:2048 lds
    s_add_u32 s3, s45, 18432
    buffer_load_dwordx4 v10, s[40:43], s3 offen offset:3072 lds
    s_add_u32 m0, s62, 4096
    s_add_u32 s3, s45, 28672
    buffer_load_dwordx4 v10, s[40:43], s3 offen offset:0 lds
    s_add_u32 s3, s45, 34816
    buffer_load_dwordx4 v10, s[40:43], s3 offen offset:1024 lds
    s_add_u32 s3, s45, 40960
    buffer_load_dwordx4 v10, s[40:43], s3 offen offset:2048 lds
    s_add_u32 s3, s45, 47104
    buffer_load_dwordx4 v10, s[40:43], s3 offen offset:3072 lds
    s_add_u32 m0, s62, 8192
    s_add_u32 s3, s45, 57344
    buffer_load_dwordx4 v10, s[40:43], s3 offen offset:0 lds
    s_add_u32 s3, s45, 63488
    buffer_load_dwordx4 v10, s[40:43], s3 offen offset:1024 lds
    s_add_u32 s3, s45, 69632
    buffer_load_dwordx4 v10, s[40:43], s3 offen offset:2048 lds
    s_add_u32 s3, s45, 75776
    buffer_load_dwordx4 v10, s[40:43], s3 offen offset:3072 lds
    s_add_u32 m0, s62, 12288
    s_add_u32 s3, s45, 86016
    buffer_load_dwordx4 v10, s[40:43], s3 offen offset:0 lds
    s_add_u32 s3, s45, 92160
    buffer_load_dwordx4 v10, s[40:43], s3 offen offset:1024 lds
    s_add_u32 s3, s45, 98304
    buffer_load_dwordx4 v10, s[40:43], s3 offen offset:2048 lds
    s_waitcnt lgkmcnt(0)
    ds_read_b64_tr_b16 v[152:153], v11 offset:10240
    ds_read_b64_tr_b16 v[154:155], v11 offset:11264
    ds_read_b64_tr_b16 v[156:157], v12 offset:10240
    ds_read_b64_tr_b16 v[158:159], v12 offset:11264
    v_mfma_f32_32x32x16_bf16 v[16:31], v[144:147], v[112:115], v[16:31]
    s_bfe_u32 s3, s37, 0x40010
    s_mul_i32 s3, s3, 28672
    s_add_u32 m0, s46, 8192
    s_add_u32 s3, s3, s44
    buffer_load_dwordx4 v10, s[32:35], s3 offen lds
    s_add_u32 s3, s3, 6144
    buffer_load_dwordx4 v10, s[32:35], s3 offen offset:1024 lds
    v_mfma_f32_32x32x16_bf16 v[32:47], v[148:151], v[112:115], v[32:47]
    s_bfe_u32 s3, s37, 0x40010
    s_lshl_b32 s3, s3, 11
    s_add_u32 s3, s3, s47
    buffer_load_dwordx4 v[112:115], v9, s[28:31], s3 offen offset:0 sc1
    v_mfma_f32_32x32x16_bf16 v[48:63], v[144:147], v[116:119], v[48:63]
    v_mfma_f32_32x32x16_bf16 v[64:79], v[148:151], v[116:119], v[64:79]
    s_bfe_u32 s3, s37, 0x40010
    s_lshl_b32 s3, s3, 11
    s_add_u32 s3, s3, s47
    s_add_u32 s3, s3, 114688
    buffer_load_dwordx4 v[116:119], v9, s[28:31], s3 offen offset:0 sc1
    s_waitcnt vmcnt(41)
    s_waitcnt lgkmcnt(0)
    ds_read_b64_tr_b16 v[144:145], v11 offset:12288
    ds_read_b64_tr_b16 v[146:147], v11 offset:13312
    ds_read_b64_tr_b16 v[148:149], v12 offset:12288
    ds_read_b64_tr_b16 v[150:151], v12 offset:13312
    v_mfma_f32_32x32x16_bf16 v[16:31], v[152:155], v[120:123], v[16:31]
    s_bfe_u32 s3, s37, 0x40010
    s_mul_i32 s3, s3, 28672
    s_add_u32 m0, s46, 10240
    s_add_u32 s3, s3, s44
    s_add_u32 s3, s3, 14336
    buffer_load_dwordx4 v10, s[32:35], s3 offen lds
    s_add_u32 s3, s3, 6144
    buffer_load_dwordx4 v10, s[32:35], s3 offen offset:1024 lds
    v_mfma_f32_32x32x16_bf16 v[32:47], v[156:159], v[120:123], v[32:47]
    s_bfe_u32 s3, s37, 0x40010
    s_lshl_b32 s3, s3, 11
    s_add_u32 s3, s3, s47
    buffer_load_dwordx4 v[120:123], v9, s[28:31], s3 offen offset:1024 sc1
    v_mfma_f32_32x32x16_bf16 v[48:63], v[152:155], v[124:127], v[48:63]
    v_mfma_f32_32x32x16_bf16 v[64:79], v[156:159], v[124:127], v[64:79]
    s_bfe_u32 s3, s37, 0x40010
    s_lshl_b32 s3, s3, 11
    s_add_u32 s3, s3, s47
    s_add_u32 s3, s3, 114688
    buffer_load_dwordx4 v[124:127], v9, s[28:31], s3 offen offset:1024 sc1
    s_waitcnt vmcnt(41)
    s_waitcnt lgkmcnt(0)
    ds_read_b64_tr_b16 v[152:153], v11 offset:14336
    ds_read_b64_tr_b16 v[154:155], v11 offset:15360
    ds_read_b64_tr_b16 v[156:157], v12 offset:14336
    ds_read_b64_tr_b16 v[158:159], v12 offset:15360
    v_mfma_f32_32x32x16_bf16 v[16:31], v[144:147], v[128:131], v[16:31]
    s_bfe_u32 s3, s37, 0x40014
    s_mul_i32 s3, s3, 28672
    s_add_u32 m0, s46, 12288
    s_add_u32 s3, s3, s44
    buffer_load_dwordx4 v10, s[32:35], s3 offen lds
    s_add_u32 s3, s3, 6144
    buffer_load_dwordx4 v10, s[32:35], s3 offen offset:1024 lds
    v_mfma_f32_32x32x16_bf16 v[32:47], v[148:151], v[128:131], v[32:47]
    s_bfe_u32 s3, s37, 0x40014
    s_lshl_b32 s3, s3, 11
    s_add_u32 s3, s3, s47
    buffer_load_dwordx4 v[128:131], v9, s[28:31], s3 offen offset:0 sc1
    v_mfma_f32_32x32x16_bf16 v[48:63], v[144:147], v[132:135], v[48:63]
    v_mfma_f32_32x32x16_bf16 v[64:79], v[148:151], v[132:135], v[64:79]
    s_bfe_u32 s3, s37, 0x40014
    s_lshl_b32 s3, s3, 11
    s_add_u32 s3, s3, s47
    s_add_u32 s3, s3, 114688
    buffer_load_dwordx4 v[132:135], v9, s[28:31], s3 offen offset:0 sc1
    s_barrier
    s_waitcnt vmcnt(41)
    s_waitcnt lgkmcnt(0)
    ds_read_b64_tr_b16 v[144:145], v11 offset:0
    ds_read_b64_tr_b16 v[146:147], v11 offset:1024
    ds_read_b64_tr_b16 v[148:149], v12 offset:0
    ds_read_b64_tr_b16 v[150:151], v12 offset:1024
    v_mfma_f32_32x32x16_bf16 v[16:31], v[152:155], v[136:139], v[16:31]
    s_bfe_u32 s3, s37, 0x40014
    s_mul_i32 s3, s3, 28672
    s_add_u32 m0, s46, 14336
    s_add_u32 s3, s3, s44
    s_add_u32 s3, s3, 14336
    buffer_load_dwordx4 v10, s[32:35], s3 offen lds
    s_add_u32 s3, s3, 6144
    buffer_load_dwordx4 v10, s[32:35], s3 offen offset:1024 lds
    v_mfma_f32_32x32x16_bf16 v[32:47], v[156:159], v[136:139], v[32:47]
    s_bfe_u32 s3, s37, 0x40014
    s_lshl_b32 s3, s3, 11
    s_add_u32 s3, s3, s47
    buffer_load_dwordx4 v[136:139], v9, s[28:31], s3 offen offset:1024 sc1
    v_mfma_f32_32x32x16_bf16 v[48:63], v[152:155], v[140:143], v[48:63]
    v_mfma_f32_32x32x16_bf16 v[64:79], v[156:159], v[140:143], v[64:79]
    s_bfe_u32 s3, s37, 0x40014
    s_lshl_b32 s3, s3, 11
    s_add_u32 s3, s3, s47
    s_add_u32 s3, s3, 114688
    buffer_load_dwordx4 v[140:143], v9, s[28:31], s3 offen offset:1024 sc1
    s_waitcnt vmcnt(41)
    s_waitcnt lgkmcnt(0)
    ds_read_b64_tr_b16 v[152:153], v11 offset:2048
    ds_read_b64_tr_b16 v[154:155], v11 offset:3072
    ds_read_b64_tr_b16 v[156:157], v12 offset:2048
    ds_read_b64_tr_b16 v[158:159], v12 offset:3072
    v_mfma_f32_32x32x16_bf16 v[16:31], v[144:147], v[80:83], v[16:31]
    s_bfe_u32 s3, s37, 0x40018
    s_mul_i32 s3, s3, 28672
    s_add_u32 m0, s46, 0
    s_add_u32 s3, s3, s44
    buffer_load_dwordx4 v10, s[32:35], s3 offen lds
    s_add_u32 s3, s3, 6144
    buffer_load_dwordx4 v10, s[32:35], s3 offen offset:1024 lds
    v_mfma_f32_32x32x16_bf16 v[32:47], v[148:151], v[80:83], v[32:47]
    s_bfe_u32 s3, s37, 0x40018
    s_lshl_b32 s3, s3, 11
    s_add_u32 s3, s3, s47
    buffer_load_dwordx4 v[80:83], v9, s[28:31], s3 offen offset:0 sc1
    v_mfma_f32_32x32x16_bf16 v[48:63], v[144:147], v[84:87], v[48:63]
    v_mfma_f32_32x32x16_bf16 v[64:79], v[148:151], v[84:87], v[64:79]
    s_bfe_u32 s3, s37, 0x40018
    s_lshl_b32 s3, s3, 11
    s_add_u32 s3, s3, s47
    s_add_u32 s3, s3, 114688
    buffer_load_dwordx4 v[84:87], v9, s[28:31], s3 offen offset:0 sc1
    s_waitcnt vmcnt(41)
    s_waitcnt lgkmcnt(0)
    ds_read_b64_tr_b16 v[144:145], v11 offset:4096
    ds_read_b64_tr_b16 v[146:147], v11 offset:5120
    ds_read_b64_tr_b16 v[148:149], v12 offset:4096
    ds_read_b64_tr_b16 v[150:151], v12 offset:5120
    v_mfma_f32_32x32x16_bf16 v[16:31], v[152:155], v[88:91], v[16:31]
    s_bfe_u32 s3, s37, 0x40018
    s_mul_i32 s3, s3, 28672
    s_add_u32 m0, s46, 2048
    s_add_u32 s3, s3, s44
    s_add_u32 s3, s3, 14336
    buffer_load_dwordx4 v10, s[32:35], s3 offen lds
    s_add_u32 s3, s3, 6144
    buffer_load_dwordx4 v10, s[32:35], s3 offen offset:1024 lds
    v_mfma_f32_32x32x16_bf16 v[32:47], v[156:159], v[88:91], v[32:47]
    s_bfe_u32 s3, s37, 0x40018
    s_lshl_b32 s3, s3, 11
    s_add_u32 s3, s3, s47
    buffer_load_dwordx4 v[88:91], v9, s[28:31], s3 offen offset:1024 sc1
    v_mfma_f32_32x32x16_bf16 v[48:63], v[152:155], v[92:95], v[48:63]
    v_mfma_f32_32x32x16_bf16 v[64:79], v[156:159], v[92:95], v[64:79]
    s_bfe_u32 s3, s37, 0x40018
    s_lshl_b32 s3, s3, 11
    s_add_u32 s3, s3, s47
    s_add_u32 s3, s3, 114688
    buffer_load_dwordx4 v[92:95], v9, s[28:31], s3 offen offset:1024 sc1
    s_waitcnt vmcnt(41)
    s_waitcnt lgkmcnt(0)
    ds_read_b64_tr_b16 v[152:153], v11 offset:6144
    ds_read_b64_tr_b16 v[154:155], v11 offset:7168
    ds_read_b64_tr_b16 v[156:157], v12 offset:6144
    ds_read_b64_tr_b16 v[158:159], v12 offset:7168
    v_mfma_f32_32x32x16_bf16 v[16:31], v[144:147], v[96:99], v[16:31]
    s_bfe_u32 s3, s37, 0x4001c
    s_mul_i32 s3, s3, 28672
    s_add_u32 m0, s46, 4096
    s_add_u32 s3, s3, s44
    buffer_load_dwordx4 v10, s[32:35], s3 offen lds
    s_add_u32 s3, s3, 6144
    buffer_load_dwordx4 v10, s[32:35], s3 offen offset:1024 lds
    v_mfma_f32_32x32x16_bf16 v[32:47], v[148:151], v[96:99], v[32:47]
    s_bfe_u32 s3, s37, 0x4001c
    s_lshl_b32 s3, s3, 11
    s_add_u32 s3, s3, s47
    buffer_load_dwordx4 v[96:99], v9, s[28:31], s3 offen offset:0 sc1
    v_mfma_f32_32x32x16_bf16 v[48:63], v[144:147], v[100:103], v[48:63]
    v_mfma_f32_32x32x16_bf16 v[64:79], v[148:151], v[100:103], v[64:79]
    s_bfe_u32 s3, s37, 0x4001c
    s_lshl_b32 s3, s3, 11
    s_add_u32 s3, s3, s47
    s_add_u32 s3, s3, 114688
    buffer_load_dwordx4 v[100:103], v9, s[28:31], s3 offen offset:0 sc1
    s_lshl_b32 s3, s56, 8
    s_add_u32 s3, s3, 20971520
    buffer_load_dword v166, v3, s[28:31], s3 offen sc1
    buffer_load_dword v167, v3, s[28:31], s3 offen offset:128 sc1
    s_barrier
    s_setprio 0
    s_waitcnt vmcnt(28)
    s_waitcnt lgkmcnt(0)
    ds_read_b64_tr_b16 v[144:145], v11 offset:8192
    ds_read_b64_tr_b16 v[146:147], v11 offset:9216
    ds_read_b64_tr_b16 v[148:149], v12 offset:8192
    ds_read_b64_tr_b16 v[150:151], v12 offset:9216
    v_mfma_f32_32x32x16_bf16 v[16:31], v[152:155], v[104:107], v[16:31]
    s_bfe_u32 s3, s37, 0x4001c
    s_mul_i32 s3, s3, 28672
    s_add_u32 m0, s46, 6144
    s_add_u32 s3, s3, s44
    s_add_u32 s3, s3, 14336
    buffer_load_dwordx4 v10, s[32:35], s3 offen lds
    s_add_u32 s3, s3, 6144
    buffer_load_dwordx4 v10, s[32:35], s3 offen offset:1024 lds
    v_mfma_f32_32x32x16_bf16 v[32:47], v[156:159], v[104:107], v[32:47]
    s_bfe_u32 s3, s37, 0x4001c
    s_lshl_b32 s3, s3, 11
    s_add_u32 s3, s3, s47
    buffer_load_dwordx4 v[104:107], v9, s[28:31], s3 offen offset:1024 sc1
    v_mfma_f32_32x32x16_bf16 v[48:63], v[152:155], v[108:111], v[48:63]
    v_mfma_f32_32x32x16_bf16 v[64:79], v[156:159], v[108:111], v[64:79]
    s_bfe_u32 s3, s37, 0x4001c
    s_lshl_b32 s3, s3, 11
    s_add_u32 s3, s3, s47
    s_add_u32 s3, s3, 114688
    buffer_load_dwordx4 v[108:111], v9, s[28:31], s3 offen offset:1024 sc1
    s_waitcnt vmcnt(28)
    s_waitcnt lgkmcnt(0)
    ds_read_b64_tr_b16 v[152:153], v11 offset:10240
    ds_read_b64_tr_b16 v[154:155], v11 offset:11264
    ds_read_b64_tr_b16 v[156:157], v12 offset:10240
    ds_read_b64_tr_b16 v[158:159], v12 offset:11264
    v_mfma_f32_32x32x16_bf16 v[16:31], v[144:147], v[112:115], v[16:31]
    v_mfma_f32_32x32x16_bf16 v[32:47], v[148:151], v[112:115], v[32:47]
    v_mfma_f32_32x32x16_bf16 v[48:63], v[144:147], v[116:119], v[48:63]
    v_mfma_f32_32x32x16_bf16 v[64:79], v[148:151], v[116:119], v[64:79]
    s_waitcnt vmcnt(24)
    s_waitcnt lgkmcnt(0)
    ds_read_b64_tr_b16 v[144:145], v11 offset:12288
    ds_read_b64_tr_b16 v[146:147], v11 offset:13312
    ds_read_b64_tr_b16 v[148:149], v12 offset:12288
    ds_read_b64_tr_b16 v[150:151], v12 offset:13312
    v_mfma_f32_32x32x16_bf16 v[16:31], v[152:155], v[120:123], v[16:31]
    v_mfma_f32_32x32x16_bf16 v[32:47], v[156:159], v[120:123], v[32:47]
    v_mfma_f32_32x32x16_bf16 v[48:63], v[152:155], v[124:127], v[48:63]
    v_mfma_f32_32x32x16_bf16 v[64:79], v[156:159], v[124:127], v[64:79]
    s_waitcnt vmcnt(20)
    s_waitcnt lgkmcnt(0)
    ds_read_b64_tr_b16 v[152:153], v11 offset:14336
    ds_read_b64_tr_b16 v[154:155], v11 offset:15360
    ds_read_b64_tr_b16 v[156:157], v12 offset:14336
    ds_read_b64_tr_b16 v[158:159], v12 offset:15360
    v_mfma_f32_32x32x16_bf16 v[16:31], v[144:147], v[128:131], v[16:31]
    v_mfma_f32_32x32x16_bf16 v[32:47], v[148:151], v[128:131], v[32:47]
    v_mfma_f32_32x32x16_bf16 v[48:63], v[144:147], v[132:135], v[48:63]
    v_mfma_f32_32x32x16_bf16 v[64:79], v[148:151], v[132:135], v[64:79]
    s_waitcnt vmcnt(16)
    s_waitcnt lgkmcnt(0)
    ds_read_b64_tr_b16 v[144:145], v11 offset:0
    ds_read_b64_tr_b16 v[146:147], v11 offset:1024
    ds_read_b64_tr_b16 v[148:149], v12 offset:0
    ds_read_b64_tr_b16 v[150:151], v12 offset:1024
    v_mfma_f32_32x32x16_bf16 v[16:31], v[152:155], v[136:139], v[16:31]
    v_mfma_f32_32x32x16_bf16 v[32:47], v[156:159], v[136:139], v[32:47]
    v_mfma_f32_32x32x16_bf16 v[48:63], v[152:155], v[140:143], v[48:63]
    v_mfma_f32_32x32x16_bf16 v[64:79], v[156:159], v[140:143], v[64:79]
    s_waitcnt vmcnt(12)
    s_waitcnt lgkmcnt(0)
    ds_read_b64_tr_b16 v[152:153], v11 offset:2048
    ds_read_b64_tr_b16 v[154:155], v11 offset:3072
    ds_read_b64_tr_b16 v[156:157], v12 offset:2048
    ds_read_b64_tr_b16 v[158:159], v12 offset:3072
    v_mfma_f32_32x32x16_bf16 v[16:31], v[144:147], v[80:83], v[16:31]
    v_mfma_f32_32x32x16_bf16 v[32:47], v[148:151], v[80:83], v[32:47]
    buffer_load_dwordx4 v[112:115], v9, s[28:31], s64 offen offset:0 sc1
    v_mfma_f32_32x32x16_bf16 v[48:63], v[144:147], v[84:87], v[48:63]
    v_mfma_f32_32x32x16_bf16 v[64:79], v[148:151], v[84:87], v[64:79]
    buffer_load_dwordx4 v[116:119], v9, s[28:31], s65 offen offset:0 sc1
    s_waitcnt vmcnt(10)
    s_waitcnt lgkmcnt(0)
    ds_read_b64_tr_b16 v[144:145], v11 offset:4096
    ds_read_b64_tr_b16 v[146:147], v11 offset:5120
    ds_read_b64_tr_b16 v[148:149], v12 offset:4096
    ds_read_b64_tr_b16 v[150:151], v12 offset:5120
    v_mfma_f32_32x32x16_bf16 v[16:31], v[152:155], v[88:91], v[16:31]
    v_mfma_f32_32x32x16_bf16 v[32:47], v[156:159], v[88:91], v[32:47]
    buffer_load_dwordx4 v[120:123], v9, s[28:31], s64 offen offset:1024 sc1
    v_mfma_f32_32x32x16_bf16 v[48:63], v[152:155], v[92:95], v[48:63]
    v_mfma_f32_32x32x16_bf16 v[64:79], v[156:159], v[92:95], v[64:79]
    buffer_load_dwordx4 v[124:127], v9, s[28:31], s65 offen offset:1024 sc1
    s_waitcnt vmcnt(6)
    s_waitcnt lgkmcnt(0)
    ds_read_b64_tr_b16 v[152:153], v11 offset:6144
    ds_read_b64_tr_b16 v[154:155], v11 offset:7168
    ds_read_b64_tr_b16 v[156:157], v12 offset:6144
    ds_read_b64_tr_b16 v[158:159], v12 offset:7168
    v_mfma_f32_32x32x16_bf16 v[16:31], v[144:147], v[96:99], v[16:31]
    v_mfma_f32_32x32x16_bf16 v[32:47], v[148:151], v[96:99], v[32:47]
    buffer_load_dwordx4 v[128:131], v9, s[28:31], s64 offen offset:2048 sc1
    v_mfma_f32_32x32x16_bf16 v[48:63], v[144:147], v[100:103], v[48:63]
    v_mfma_f32_32x32x16_bf16 v[64:79], v[148:151], v[100:103], v[64:79]
    buffer_load_dwordx4 v[132:135], v9, s[28:31], s65 offen offset:2048 sc1
    s_waitcnt vmcnt(6)
    s_waitcnt lgkmcnt(0)
    v_mfma_f32_32x32x16_bf16 v[16:31], v[152:155], v[104:107], v[16:31]
    v_mfma_f32_32x32x16_bf16 v[32:47], v[156:159], v[104:107], v[32:47]
    buffer_load_dwordx4 v[136:139], v9, s[28:31], s64 offen offset:3072 sc1
    v_mfma_f32_32x32x16_bf16 v[48:63], v[152:155], v[108:111], v[48:63]
    v_mfma_f32_32x32x16_bf16 v[64:79], v[156:159], v[108:111], v[64:79]
    buffer_load_dwordx4 v[140:143], v9, s[28:31], s65 offen offset:3072 sc1
    buffer_load_dwordx4 v[80:83], v9, s[28:31], s66 offen offset:0 sc1
    buffer_load_dwordx4 v[84:87], v9, s[28:31], s67 offen offset:0 sc1
    buffer_load_dwordx4 v[88:91], v9, s[28:31], s66 offen offset:1024 sc1
    buffer_load_dwordx4 v[92:95], v9, s[28:31], s67 offen offset:1024 sc1
    buffer_load_dwordx4 v[96:99], v9, s[28:31], s66 offen offset:2048 sc1
    buffer_load_dwordx4 v[100:103], v9, s[28:31], s67 offen offset:2048 sc1
    buffer_load_dwordx4 v[104:107], v9, s[28:31], s66 offen offset:3072 sc1
    buffer_load_dwordx4 v[108:111], v9, s[28:31], s67 offen offset:3072 sc1
    v_xor_b32 v6, 64, v2
    v_xor_b32 v7, 64, v4
    v_xor_b32 v8, 64, v5
    v_xor_b32 v15, 64, v160
    ds_read_b64_tr_b16 v[144:145], v2 offset:0
    ds_read_b64_tr_b16 v[146:147], v4 offset:0
    ds_read_b64_tr_b16 v[148:149], v6 offset:0
    ds_read_b64_tr_b16 v[150:151], v7 offset:0
    s_mov_b32 s32, s20
    s_and_b32 s33, s21, 0xffff
    s_mov_b32 s34, 1835008
    s_mov_b32 s35, 0x20000
    v_sub_f32 v10, 1.0, v166
    v_sub_f32 v166, 1.0, v167
    v_mov_b32 v11, v10
    v_mov_b32 v167, v166
    s_mov_b32 s59, 15
    s_mov_b32 s69, 0x40000
    v_pk_mul_f32 v[16:17], v[16:17], v[10:11]
    v_pk_mul_f32 v[18:19], v[18:19], v[10:11]
    v_pk_mul_f32 v[20:21], v[20:21], v[10:11]
    v_pk_mul_f32 v[22:23], v[22:23], v[10:11]
    v_pk_mul_f32 v[24:25], v[24:25], v[10:11]
    v_pk_mul_f32 v[26:27], v[26:27], v[10:11]
    v_pk_mul_f32 v[28:29], v[28:29], v[10:11]
    v_pk_mul_f32 v[30:31], v[30:31], v[10:11]
    v_pk_mul_f32 v[32:33], v[32:33], v[10:11]
    v_pk_mul_f32 v[34:35], v[34:35], v[10:11]
    v_pk_mul_f32 v[36:37], v[36:37], v[10:11]
    v_pk_mul_f32 v[38:39], v[38:39], v[10:11]
    v_pk_mul_f32 v[40:41], v[40:41], v[10:11]
    v_pk_mul_f32 v[42:43], v[42:43], v[10:11]
    v_pk_mul_f32 v[44:45], v[44:45], v[10:11]
    v_pk_mul_f32 v[46:47], v[46:47], v[10:11]
    v_pk_mul_f32 v[48:49], v[48:49], v[166:167]
    v_pk_mul_f32 v[50:51], v[50:51], v[166:167]
    v_pk_mul_f32 v[52:53], v[52:53], v[166:167]
    v_pk_mul_f32 v[54:55], v[54:55], v[166:167]
    v_pk_mul_f32 v[56:57], v[56:57], v[166:167]
    v_pk_mul_f32 v[58:59], v[58:59], v[166:167]
    v_pk_mul_f32 v[60:61], v[60:61], v[166:167]
    v_pk_mul_f32 v[62:63], v[62:63], v[166:167]
    v_pk_mul_f32 v[64:65], v[64:65], v[166:167]
    v_pk_mul_f32 v[66:67], v[66:67], v[166:167]
    v_pk_mul_f32 v[68:69], v[68:69], v[166:167]
    v_pk_mul_f32 v[70:71], v[70:71], v[166:167]
    v_pk_mul_f32 v[72:73], v[72:73], v[166:167]
    v_pk_mul_f32 v[74:75], v[74:75], v[166:167]
    v_pk_mul_f32 v[76:77], v[76:77], v[166:167]
    v_pk_mul_f32 v[78:79], v[78:79], v[166:167]
    ds_read_b64_tr_b16 v[152:153], v5 offset:0
    ds_read_b64_tr_b16 v[154:155], v160 offset:0
    ds_read_b64_tr_b16 v[156:157], v8 offset:0
    ds_read_b64_tr_b16 v[158:159], v15 offset:0
    s_waitcnt vmcnt(12)
    v_xor_b32 v115, v115, v161
    v_xor_b32 v119, v119, v161
    v_xor_b32 v123, v123, v161
    v_xor_b32 v127, v127, v161
    v_or3_b32 v163, v115, v119, v123
    v_or_b32 v163, v163, v127
    v_cmp_gt_u32 vcc, 0x10000, v163
    s_waitcnt lgkmcnt(0)
    s_cmp_eq_u64 vcc, -1
    s_cbranch_scc0 OSK_9
    s_bitset0_b32 s59, 0
    v_mfma_f32_32x32x16_bf16 v[16:31], v[144:147], v[112:115], v[16:31]
    v_mfma_f32_32x32x16_bf16 v[32:47], v[148:151], v[112:115], v[32:47]
    v_mfma_f32_32x32x16_bf16 v[48:63], v[144:147], v[116:119], v[48:63]
    v_mfma_f32_32x32x16_bf16 v[64:79], v[148:151], v[116:119], v[64:79]
    ds_read_b64_tr_b16 v[144:145], v2 offset:3584
    ds_read_b64_tr_b16 v[146:147], v4 offset:3584
    ds_read_b64_tr_b16 v[148:149], v6 offset:3584
    ds_read_b64_tr_b16 v[150:151], v7 offset:3584
    v_mfma_f32_32x32x16_bf16 v[16:31], v[152:155], v[120:123], v[16:31]
    v_mfma_f32_32x32x16_bf16 v[32:47], v[156:159], v[120:123], v[32:47]
    v_mfma_f32_32x32x16_bf16 v[48:63], v[152:155], v[124:127], v[48:63]
    v_mfma_f32_32x32x16_bf16 v[64:79], v[156:159], v[124:127], v[64:79]
    s_branch OJN_10
OSK_9:
    ds_read_b64_tr_b16 v[144:145], v2 offset:3584
    ds_read_b64_tr_b16 v[146:147], v4 offset:3584
    ds_read_b64_tr_b16 v[148:149], v6 offset:3584
    ds_read_b64_tr_b16 v[150:151], v7 offset:3584
OJN_10:
    ds_read_b64_tr_b16 v[152:153], v5 offset:3584
    ds_read_b64_tr_b16 v[154:155], v160 offset:3584
    ds_read_b64_tr_b16 v[156:157], v8 offset:3584
    ds_read_b64_tr_b16 v[158:159], v15 offset:3584
    s_waitcnt vmcnt(8)
    v_xor_b32 v131, v131, v161
    v_xor_b32 v135, v135, v161
    v_xor_b32 v139, v139, v161
    v_xor_b32 v143, v143, v161
    v_or3_b32 v163, v131, v135, v139
    v_or_b32 v163, v163, v143
    v_cmp_gt_u32 vcc, 0x10000, v163
    s_waitcnt lgkmcnt(0)
    s_cmp_eq_u64 vcc, -1
    s_cbranch_scc0 OSK_11
    s_bitset0_b32 s59, 1
    v_mfma_f32_32x32x16_bf16 v[16:31], v[144:147], v[128:131], v[16:31]
    v_mfma_f32_32x32x16_bf16 v[32:47], v[148:151], v[128:131], v[32:47]
    v_mfma_f32_32x32x16_bf16 v[48:63], v[144:147], v[132:135], v[48:63]
    v_mfma_f32_32x32x16_bf16 v[64:79], v[148:151], v[132:135], v[64:79]
    ds_read_b64_tr_b16 v[144:145], v2 offset:7168
    ds_read_b64_tr_b16 v[146:147], v4 offset:7168
    ds_read_b64_tr_b16 v[148:149], v6 offset:7168
    ds_read_b64_tr_b16 v[150:151], v7 offset:7168
    v_mfma_f32_32x32x16_bf16 v[16:31], v[152:155], v[136:139], v[16:31]
    v_mfma_f32_32x32x16_bf16 v[32:47], v[156:159], v[136:139], v[32:47]
    v_mfma_f32_32x32x16_bf16 v[48:63], v[152:155], v[140:143], v[48:63]
    v_mfma_f32_32x32x16_bf16 v[64:79], v[156:159], v[140:143], v[64:79]
    s_branch OJN_12
OSK_11:
    ds_read_b64_tr_b16 v[144:145], v2 offset:7168
    ds_read_b64_tr_b16 v[146:147], v4 offset:7168
    ds_read_b64_tr_b16 v[148:149], v6 offset:7168
    ds_read_b64_tr_b16 v[150:151], v7 offset:7168
OJN_12:
    ds_read_b64_tr_b16 v[152:153], v5 offset:7168
    ds_read_b64_tr_b16 v[154:155], v160 offset:7168
    ds_read_b64_tr_b16 v[156:157], v8 offset:7168
    ds_read_b64_tr_b16 v[158:159], v15 offset:7168
    s_waitcnt vmcnt(4)
    v_xor_b32 v83, v83, v161
    v_xor_b32 v87, v87, v161
    v_xor_b32 v91, v91, v161
    v_xor_b32 v95, v95, v161
    v_or3_b32 v163, v83, v87, v91
    v_or_b32 v163, v163, v95
    v_cmp_gt_u32 vcc, 0x10000, v163
    s_waitcnt lgkmcnt(0)
    s_cmp_eq_u64 vcc, -1
    s_cbranch_scc0 OSK_13
    s_bitset0_b32 s59, 2
    v_mfma_f32_32x32x16_bf16 v[16:31], v[144:147], v[80:83], v[16:31]
    v_mfma_f32_32x32x16_bf16 v[32:47], v[148:151], v[80:83], v[32:47]
    v_mfma_f32_32x32x16_bf16 v[48:63], v[144:147], v[84:87], v[48:63]
    v_mfma_f32_32x32x16_bf16 v[64:79], v[148:151], v[84:87], v[64:79]
    ds_read_b64_tr_b16 v[144:145], v2 offset:10752
    ds_read_b64_tr_b16 v[146:147], v4 offset:10752
    ds_read_b64_tr_b16 v[148:149], v6 offset:10752
    ds_read_b64_tr_b16 v[150:151], v7 offset:10752
    v_mfma_f32_32x32x16_bf16 v[16:31], v[152:155], v[88:91], v[16:31]
    v_mfma_f32_32x32x16_bf16 v[32:47], v[156:159], v[88:91], v[32:47]
    v_mfma_f32_32x32x16_bf16 v[48:63], v[152:155], v[92:95], v[48:63]
    v_mfma_f32_32x32x16_bf16 v[64:79], v[156:159], v[92:95], v[64:79]
    s_branch OJN_14
OSK_13:
    ds_read_b64_tr_b16 v[144:145], v2 offset:10752
    ds_read_b64_tr_b16 v[146:147], v4 offset:10752
    ds_read_b64_tr_b16 v[148:149], v6 offset:10752
    ds_read_b64_tr_b16 v[150:151], v7 offset:10752
OJN_14:
    ds_read_b64_tr_b16 v[152:153], v5 offset:10752
    ds_read_b64_tr_b16 v[154:155], v160 offset:10752
    ds_read_b64_tr_b16 v[156:157], v8 offset:10752
    ds_read_b64_tr_b16 v[158:159], v15 offset:10752
    s_waitcnt vmcnt(0)
    v_xor_b32 v99, v99, v161
    v_xor_b32 v103, v103, v161
    v_xor_b32 v107, v107, v161
    v_xor_b32 v111, v111, v161
    v_or3_b32 v163, v99, v103, v107
    v_or_b32 v163, v163, v111
    v_cmp_gt_u32 vcc, 0x10000, v163
    s_waitcnt lgkmcnt(0)
    s_cmp_eq_u64 vcc, -1
    s_cbranch_scc0 OSK_15
    s_bitset0_b32 s59, 3
    v_mfma_f32_32x32x16_bf16 v[16:31], v[144:147], v[96:99], v[16:31]
    v_mfma_f32_32x32x16_bf16 v[32:47], v[148:151], v[96:99], v[32:47]
    v_mfma_f32_32x32x16_bf16 v[48:63], v[144:147], v[100:103], v[48:63]
    v_mfma_f32_32x32x16_bf16 v[64:79], v[148:151], v[100:103], v[64:79]
    v_mfma_f32_32x32x16_bf16 v[16:31], v[152:155], v[104:107], v[16:31]
    v_mfma_f32_32x32x16_bf16 v[32:47], v[156:159], v[104:107], v[32:47]
    v_mfma_f32_32x32x16_bf16 v[48:63], v[152:155], v[108:111], v[48:63]
    v_mfma_f32_32x32x16_bf16 v[64:79], v[156:159], v[108:111], v[64:79]
OSK_15:
    s_cmp_eq_u32 s59, 0
    s_cbranch_scc1 O_DONE
O_LOOP:
    s_bitcmp1_b32 s59, 0
    s_cbranch_scc0 OSK_17
    buffer_load_dwordx4 v[112:115], v9, s[28:31], s64 offen offset:0 sc1
    buffer_load_dwordx4 v[116:119], v9, s[28:31], s65 offen offset:0 sc1
    buffer_load_dwordx4 v[120:123], v9, s[28:31], s64 offen offset:1024 sc1
    buffer_load_dwordx4 v[124:127], v9, s[28:31], s65 offen offset:1024 sc1
OSK_17:
    s_bitcmp1_b32 s59, 1
    s_cbranch_scc0 OSK_18
    buffer_load_dwordx4 v[128:131], v9, s[28:31], s64 offen offset:2048 sc1
    buffer_load_dwordx4 v[132:135], v9, s[28:31], s65 offen offset:2048 sc1
    buffer_load_dwordx4 v[136:139], v9, s[28:31], s64 offen offset:3072 sc1
    buffer_load_dwordx4 v[140:143], v9, s[28:31], s65 offen offset:3072 sc1
OSK_18:
    s_bitcmp1_b32 s59, 2
    s_cbranch_scc0 OSK_19
    buffer_load_dwordx4 v[80:83], v9, s[28:31], s66 offen offset:0 sc1
    buffer_load_dwordx4 v[84:87], v9, s[28:31], s67 offen offset:0 sc1
    buffer_load_dwordx4 v[88:91], v9, s[28:31], s66 offen offset:1024 sc1
    buffer_load_dwordx4 v[92:95], v9, s[28:31], s67 offen offset:1024 sc1
OSK_19:
    s_bitcmp1_b32 s59, 3
    s_cbranch_scc0 OSK_20
    buffer_load_dwordx4 v[96:99], v9, s[28:31], s66 offen offset:2048 sc1
    buffer_load_dwordx4 v[100:103], v9, s[28:31], s67 offen offset:2048 sc1
    buffer_load_dwordx4 v[104:107], v9, s[28:31], s66 offen offset:3072 sc1
    buffer_load_dwordx4 v[108:111], v9, s[28:31], s67 offen offset:3072 sc1
OSK_20:
O_CHECK:
    s_mov_b32 s61, 0
    s_waitcnt vmcnt(0)
    v_xor_b32 v115, v115, v161
    v_xor_b32 v119, v119, v161
    v_xor_b32 v123, v123, v161
    v_xor_b32 v127, v127, v161
    v_or3_b32 v163, v115, v119, v123
    v_or_b32 v163, v163, v127
    v_cmp_gt_u32 vcc, 0x10000, v163
    s_nop 0
    s_cmp_eq_u64 vcc, -1
    s_cselect_b32 s3, 1, 0
    s_or_b32 s61, s61, s3
    v_xor_b32 v131, v131, v161
    v_xor_b32 v135, v135, v161
    v_xor_b32 v139, v139, v161
    v_xor_b32 v143, v143, v161
    v_or3_b32 v163, v131, v135, v139
    v_or_b32 v163, v163, v143
    v_cmp_gt_u32 vcc, 0x10000, v163
    s_nop 0
    s_cmp_eq_u64 vcc, -1
    s_cselect_b32 s3, 2, 0
    s_or_b32 s61, s61, s3
    v_xor_b32 v83, v83, v161
    v_xor_b32 v87, v87, v161
    v_xor_b32 v91, v91, v161
    v_xor_b32 v95, v95, v161
    v_or3_b32 v163, v83, v87, v91
    v_or_b32 v163, v163, v95
    v_cmp_gt_u32 vcc, 0x10000, v163
    s_nop 0
    s_cmp_eq_u64 vcc, -1
    s_cselect_b32 s3, 4, 0
    s_or_b32 s61, s61, s3
    v_xor_b32 v99, v99, v161
    v_xor_b32 v103, v103, v161
    v_xor_b32 v107, v107, v161
    v_xor_b32 v111, v111, v161
    v_or3_b32 v163, v99, v103, v107
    v_or_b32 v163, v163, v111
    v_cmp_gt_u32 vcc, 0x10000, v163
    s_nop 0
    s_cmp_eq_u64 vcc, -1
    s_cselect_b32 s3, 8, 0
    s_or_b32 s61, s61, s3
    s_and_b32 s61, s61, s59
    s_cbranch_scc0 O_NEXT
    s_andn2_b32 s59, s59, s61
    s_bitcmp1_b32 s61, 0
    s_cbranch_scc0 OSK_21
    ds_read_b64_tr_b16 v[144:145], v2 offset:0
    ds_read_b64_tr_b16 v[146:147], v4 offset:0
    ds_read_b64_tr_b16 v[148:149], v6 offset:0
    ds_read_b64_tr_b16 v[150:151], v7 offset:0
    ds_read_b64_tr_b16 v[152:153], v5 offset:0
    ds_read_b64_tr_b16 v[154:155], v160 offset:0
    ds_read_b64_tr_b16 v[156:157], v8 offset:0
    ds_read_b64_tr_b16 v[158:159], v15 offset:0
    s_waitcnt lgkmcnt(4)
    v_mfma_f32_32x32x16_bf16 v[16:31], v[144:147], v[112:115], v[16:31]
    v_mfma_f32_32x32x16_bf16 v[32:47], v[148:151], v[112:115], v[32:47]
    v_mfma_f32_32x32x16_bf16 v[48:63], v[144:147], v[116:119], v[48:63]
    v_mfma_f32_32x32x16_bf16 v[64:79], v[148:151], v[116:119], v[64:79]
    s_waitcnt lgkmcnt(0)
    v_mfma_f32_32x32x16_bf16 v[16:31], v[152:155], v[120:123], v[16:31]
    v_mfma_f32_32x32x16_bf16 v[32:47], v[156:159], v[120:123], v[32:47]
    v_mfma_f32_32x32x16_bf16 v[48:63], v[152:155], v[124:127], v[48:63]
    v_mfma_f32_32x32x16_bf16 v[64:79], v[156:159], v[124:127], v[64:79]
OSK_21:
    s_bitcmp1_b32 s61, 1
    s_cbranch_scc0 OSK_22
    ds_read_b64_tr_b16 v[144:145], v2 offset:3584
    ds_read_b64_tr_b16 v[146:147], v4 offset:3584
    ds_read_b64_tr_b16 v[148:149], v6 offset:3584
    ds_read_b64_tr_b16 v[150:151], v7 offset:3584
    ds_read_b64_tr_b16 v[152:153], v5 offset:3584
    ds_read_b64_tr_b16 v[154:155], v160 offset:3584
    ds_read_b64_tr_b16 v[156:157], v8 offset:3584
    ds_read_b64_tr_b16 v[158:159], v15 offset:3584
    s_waitcnt lgkmcnt(4)
    v_mfma_f32_32x32x16_bf16 v[16:31], v[144:147], v[128:131], v[16:31]
    v_mfma_f32_32x32x16_bf16 v[32:47], v[148:151], v[128:131], v[32:47]
    v_mfma_f32_32x32x16_bf16 v[48:63], v[144:147], v[132:135], v[48:63]
    v_mfma_f32_32x32x16_bf16 v[64:79], v[148:151], v[132:135], v[64:79]
    s_waitcnt lgkmcnt(0)
    v_mfma_f32_32x32x16_bf16 v[16:31], v[152:155], v[136:139], v[16:31]
    v_mfma_f32_32x32x16_bf16 v[32:47], v[156:159], v[136:139], v[32:47]
    v_mfma_f32_32x32x16_bf16 v[48:63], v[152:155], v[140:143], v[48:63]
    v_mfma_f32_32x32x16_bf16 v[64:79], v[156:159], v[140:143], v[64:79]
OSK_22:
    s_bitcmp1_b32 s61, 2
    s_cbranch_scc0 OSK_23
    ds_read_b64_tr_b16 v[144:145], v2 offset:7168
    ds_read_b64_tr_b16 v[146:147], v4 offset:7168
    ds_read_b64_tr_b16 v[148:149], v6 offset:7168
    ds_read_b64_tr_b16 v[150:151], v7 offset:7168
    ds_read_b64_tr_b16 v[152:153], v5 offset:7168
    ds_read_b64_tr_b16 v[154:155], v160 offset:7168
    ds_read_b64_tr_b16 v[156:157], v8 offset:7168
    ds_read_b64_tr_b16 v[158:159], v15 offset:7168
    s_waitcnt lgkmcnt(4)
    v_mfma_f32_32x32x16_bf16 v[16:31], v[144:147], v[80:83], v[16:31]
    v_mfma_f32_32x32x16_bf16 v[32:47], v[148:151], v[80:83], v[32:47]
    v_mfma_f32_32x32x16_bf16 v[48:63], v[144:147], v[84:87], v[48:63]
    v_mfma_f32_32x32x16_bf16 v[64:79], v[148:151], v[84:87], v[64:79]
    s_waitcnt lgkmcnt(0)
    v_mfma_f32_32x32x16_bf16 v[16:31], v[152:155], v[88:91], v[16:31]
    v_mfma_f32_32x32x16_bf16 v[32:47], v[156:159], v[88:91], v[32:47]
    v_mfma_f32_32x32x16_bf16 v[48:63], v[152:155], v[92:95], v[48:63]
    v_mfma_f32_32x32x16_bf16 v[64:79], v[156:159], v[92:95], v[64:79]
OSK_23:
    s_bitcmp1_b32 s61, 3
    s_cbranch_scc0 OSK_24
    ds_read_b64_tr_b16 v[144:145], v2 offset:10752
    ds_read_b64_tr_b16 v[146:147], v4 offset:10752
    ds_read_b64_tr_b16 v[148:149], v6 offset:10752
    ds_read_b64_tr_b16 v[150:151], v7 offset:10752
    ds_read_b64_tr_b16 v[152:153], v5 offset:10752
    ds_read_b64_tr_b16 v[154:155], v160 offset:10752
    ds_read_b64_tr_b16 v[156:157], v8 offset:10752
    ds_read_b64_tr_b16 v[158:159], v15 offset:10752
    s_waitcnt lgkmcnt(4)
    v_mfma_f32_32x32x16_bf16 v[16:31], v[144:147], v[96:99], v[16:31]
    v_mfma_f32_32x32x16_bf16 v[32:47], v[148:151], v[96:99], v[32:47]
    v_mfma_f32_32x32x16_bf16 v[48:63], v[144:147], v[100:103], v[48:63]
    v_mfma_f32_32x32x16_bf16 v[64:79], v[148:151], v[100:103], v[64:79]
    s_waitcnt lgkmcnt(0)
    v_mfma_f32_32x32x16_bf16 v[16:31], v[152:155], v[104:107], v[16:31]
    v_mfma_f32_32x32x16_bf16 v[32:47], v[156:159], v[104:107], v[32:47]
    v_mfma_f32_32x32x16_bf16 v[48:63], v[152:155], v[108:111], v[48:63]
    v_mfma_f32_32x32x16_bf16 v[64:79], v[156:159], v[108:111], v[64:79]
OSK_24:
O_NEXT:
    s_cmp_eq_u32 s59, 0
    s_cbranch_scc1 O_DONE
    s_sub_u32 s69, s69, 1
    s_cbranch_scc1 O_DONE
    s_sleep 1
    s_branch O_LOOP
O_DONE:
    s_nop 8
    s_cmp_eq_u32 s49, 1
    s_cbranch_scc1 R_W1
    s_cmp_eq_u32 s49, 2
    s_cbranch_scc1 R_W2
    s_cmp_eq_u32 s49, 3
    s_cbranch_scc1 R_W3
R_W0:
    ds_write_b128 v13, v[32:35] offset:4096
    ds_write_b128 v13, v[36:39] offset:5120
    ds_write_b128 v13, v[40:43] offset:6144
    ds_write_b128 v13, v[44:47] offset:7168
    ds_write_b128 v13, v[48:51] offset:8192
    ds_write_b128 v13, v[52:55] offset:9216
    ds_write_b128 v13, v[56:59] offset:10240
    ds_write_b128 v13, v[60:63] offset:11264
    ds_write_b128 v13, v[64:67] offset:12288
    ds_write_b128 v13, v[68:71] offset:13312
    ds_write_b128 v13, v[72:75] offset:14336
    ds_write_b128 v13, v[76:79] offset:15360
    s_waitcnt lgkmcnt(0)
    s_barrier
    ds_read_b128 v[80:83], v14 offset:16384
    ds_read_b128 v[84:87], v14 offset:17408
    ds_read_b128 v[88:91], v14 offset:18432
    ds_read_b128 v[92:95], v14 offset:19456
    ds_read_b128 v[96:99], v14 offset:32768
    ds_read_b128 v[100:103], v14 offset:33792
    ds_read_b128 v[104:107], v14 offset:34816
    ds_read_b128 v[108:111], v14 offset:35840
    ds_read_b128 v[112:115], v14 offset:49152
    ds_read_b128 v[116:119], v14 offset:50176
    ds_read_b128 v[120:123], v14 offset:51200
    ds_read_b128 v[124:127], v14 offset:52224
    s_waitcnt lgkmcnt(8)
    v_pk_add_f32 v[80:81], v[80:81], v[16:17]
    v_pk_add_f32 v[82:83], v[82:83], v[18:19]
    v_pk_add_f32 v[84:85], v[84:85], v[20:21]
    v_pk_add_f32 v[86:87], v[86:87], v[22:23]
    v_pk_add_f32 v[88:89], v[88:89], v[24:25]
    v_pk_add_f32 v[90:91], v[90:91], v[26:27]
    v_pk_add_f32 v[92:93], v[92:93], v[28:29]
    v_pk_add_f32 v[94:95], v[94:95], v[30:31]
    s_branch R_JOIN
R_W1:
    ds_write_b128 v13, v[16:19] offset:0
    ds_write_b128 v13, v[20:23] offset:1024
    ds_write_b128 v13, v[24:27] offset:2048
    ds_write_b128 v13, v[28:31] offset:3072
    ds_write_b128 v13, v[48:51] offset:8192
    ds_write_b128 v13, v[52:55] offset:9216
    ds_write_b128 v13, v[56:59] offset:10240
    ds_write_b128 v13, v[60:63] offset:11264
    ds_write_b128 v13, v[64:67] offset:12288
    ds_write_b128 v13, v[68:71] offset:13312
    ds_write_b128 v13, v[72:75] offset:14336
    ds_write_b128 v13, v[76:79] offset:15360
    s_waitcnt lgkmcnt(0)
    s_barrier
    ds_read_b128 v[80:83], v14 offset:0
    ds_read_b128 v[84:87], v14 offset:1024
    ds_read_b128 v[88:91], v14 offset:2048
    ds_read_b128 v[92:95], v14 offset:3072
    ds_read_b128 v[96:99], v14 offset:32768
    ds_read_b128 v[100:103], v14 offset:33792
    ds_read_b128 v[104:107], v14 offset:34816
    ds_read_b128 v[108:111], v14 offset:35840
    ds_read_b128 v[112:115], v14 offset:49152
    ds_read_b128 v[116:119], v14 offset:50176
    ds_read_b128 v[120:123], v14 offset:51200
    ds_read_b128 v[124:127], v14 offset:52224
    s_waitcnt lgkmcnt(8)
    v_pk_add_f32 v[80:81], v[80:81], v[32:33]
    v_pk_add_f32 v[82:83], v[82:83], v[34:35]
    v_pk_add_f32 v[84:85], v[84:85], v[36:37]
    v_pk_add_f32 v[86:87], v[86:87], v[38:39]
    v_pk_add_f32 v[88:89], v[88:89], v[40:41]
    v_pk_add_f32 v[90:91], v[90:91], v[42:43]
    v_pk_add_f32 v[92:93], v[92:93], v[44:45]
    v_pk_add_f32 v[94:95], v[94:95], v[46:47]
    s_branch R_JOIN
R_W2:
    ds_write_b128 v13, v[16:19] offset:0
    ds_write_b128 v13, v[20:23] offset:1024
    ds_write_b128 v13, v[24:27] offset:2048
    ds_write_b128 v13, v[28:31] offset:3072
    ds_write_b128 v13, v[32:35] offset:4096
    ds_write_b128 v13, v[36:39] offset:5120
    ds_write_b128 v13, v[40:43] offset:6144
    ds_write_b128 v13, v[44:47] offset:7168
    ds_write_b128 v13, v[64:67] offset:12288
    ds_write_b128 v13, v[68:71] offset:13312
    ds_write_b128 v13, v[72:75] offset:14336
    ds_write_b128 v13, v[76:79] offset:15360
    s_waitcnt lgkmcnt(0)
    s_barrier
    ds_read_b128 v[80:83], v14 offset:0
    ds_read_b128 v[84:87], v14 offset:1024
    ds_read_b128 v[88:91], v14 offset:2048
    ds_read_b128 v[92:95], v14 offset:3072
    ds_read_b128 v[96:99], v14 offset:16384
    ds_read_b128 v[100:103], v14 offset:17408
    ds_read_b128 v[104:107], v14 offset:18432
    ds_read_b128 v[108:111], v14 offset:19456
    ds_read_b128 v[112:115], v14 offset:49152
    ds_read_b128 v[116:119], v14 offset:50176
    ds_read_b128 v[120:123], v14 offset:51200
    ds_read_b128 v[124:127], v14 offset:52224
    s_waitcnt lgkmcnt(8)
    v_pk_add_f32 v[80:81], v[80:81], v[48:49]
    v_pk_add_f32 v[82:83], v[82:83], v[50:51]
    v_pk_add_f32 v[84:85], v[84:85], v[52:53]
    v_pk_add_f32 v[86:87], v[86:87], v[54:55]
    v_pk_add_f32 v[88:89], v[88:89], v[56:57]
    v_pk_add_f32 v[90:91], v[90:91], v[58:59]
    v_pk_add_f32 v[92:93], v[92:93], v[60:61]
    v_pk_add_f32 v[94:95], v[94:95], v[62:63]
    s_branch R_JOIN
R_W3:
    ds_write_b128 v13, v[16:19] offset:0
    ds_write_b128 v13, v[20:23] offset:1024
    ds_write_b128 v13, v[24:27] offset:2048
    ds_write_b128 v13, v[28:31] offset:3072
    ds_write_b128 v13, v[32:35] offset:4096
    ds_write_b128 v13, v[36:39] offset:5120
    ds_write_b128 v13, v[40:43] offset:6144
    ds_write_b128 v13, v[44:47] offset:7168
    ds_write_b128 v13, v[48:51] offset:8192
    ds_write_b128 v13, v[52:55] offset:9216
    ds_write_b128 v13, v[56:59] offset:10240
    ds_write_b128 v13, v[60:63] offset:11264
    s_waitcnt lgkmcnt(0)
    s_barrier
    ds_read_b128 v[80:83], v14 offset:0
    ds_read_b128 v[84:87], v14 offset:1024
    ds_read_b128 v[88:91], v14 offset:2048
    ds_read_b128 v[92:95], v14 offset:3072
    ds_read_b128 v[96:99], v14 offset:16384
    ds_read_b128 v[100:103], v14 offset:17408
    ds_read_b128 v[104:107], v14 offset:18432
    ds_read_b128 v[108:111], v14 offset:19456
    ds_read_b128 v[112:115], v14 offset:32768
    ds_read_b128 v[116:119], v14 offset:33792
    ds_read_b128 v[120:123], v14 offset:34816
    ds_read_b128 v[124:127], v14 offset:35840
    s_waitcnt lgkmcnt(8)
    v_pk_add_f32 v[80:81], v[80:81], v[64:65]
    v_pk_add_f32 v[82:83], v[82:83], v[66:67]
    v_pk_add_f32 v[84:85], v[84:85], v[68:69]
    v_pk_add_f32 v[86:87], v[86:87], v[70:71]
    v_pk_add_f32 v[88:89], v[88:89], v[72:73]
    v_pk_add_f32 v[90:91], v[90:91], v[74:75]
    v_pk_add_f32 v[92:93], v[92:93], v[76:77]
    v_pk_add_f32 v[94:95], v[94:95], v[78:79]
R_JOIN:
    s_waitcnt lgkmcnt(0)
    v_pk_add_f32 v[96:97], v[96:97], v[112:113]
    v_pk_add_f32 v[98:99], v[98:99], v[114:115]
    v_pk_add_f32 v[100:101], v[100:101], v[116:117]
    v_pk_add_f32 v[102:103], v[102:103], v[118:119]
    v_pk_add_f32 v[104:105], v[104:105], v[120:121]
    v_pk_add_f32 v[106:107], v[106:107], v[122:123]
    v_pk_add_f32 v[108:109], v[108:109], v[124:125]
    v_pk_add_f32 v[110:111], v[110:111], v[126:127]
    v_pk_add_f32 v[80:81], v[80:81], v[96:97]
    v_pk_add_f32 v[82:83], v[82:83], v[98:99]
    v_pk_add_f32 v[84:85], v[84:85], v[100:101]
    v_pk_add_f32 v[86:87], v[86:87], v[102:103]
    v_pk_add_f32 v[88:89], v[88:89], v[104:105]
    v_pk_add_f32 v[90:91], v[90:91], v[106:107]
    v_pk_add_f32 v[92:93], v[92:93], v[108:109]
    v_pk_add_f32 v[94:95], v[94:95], v[110:111]
    v_cvt_pk_bf16_f32 v16, v80, v81
    v_cvt_pk_bf16_f32 v17, v82, v83
    v_cvt_pk_bf16_f32 v18, v84, v85
    v_cvt_pk_bf16_f32 v19, v86, v87
    v_cvt_pk_bf16_f32 v20, v88, v89
    v_cvt_pk_bf16_f32 v21, v90, v91
    v_cvt_pk_bf16_f32 v22, v92, v93
    v_cvt_pk_bf16_f32 v23, v94, v95
    s_nop 1
    v_permlane32_swap_b32 v16, v18
    v_permlane32_swap_b32 v17, v19
    v_permlane32_swap_b32 v20, v22
    v_permlane32_swap_b32 v21, v23
    buffer_store_dwordx4 v[16:19], v162, s[32:35], s63 offen offset:0
    buffer_store_dwordx4 v[20:23], v162, s[32:35], s63 offen offset:32
    s_endpgm
L_LOADER:
    v_and_b32 v3, 1, v1
    v_lshlrev_b32 v3, 3, v3
    s_add_u32 s61, s58, 22368256
    s_waitcnt vmcnt(0)
    s_barrier
    s_mov_b32 s3, 2
    s_and_b32 s3, s3, 7
    s_lshl_b32 s3, s3, 15
    s_add_u32 s3, s3, s38
    s_add_u32 m0, s39, 65536
    s_add_u32 s3, s3, 0
    buffer_load_dwordx4 v8, s[28:31], s3 offen offset:0 sc1 lds
    buffer_load_dwordx4 v8, s[28:31], s3 offen offset:1024 sc1 lds
    buffer_load_dwordx4 v8, s[28:31], s3 offen offset:2048 sc1 lds
    buffer_load_dwordx4 v8, s[28:31], s3 offen offset:3072 sc1 lds
    s_add_u32 m0, s39, 69632
    s_add_u32 s3, s3, 4096
    buffer_load_dwordx4 v8, s[28:31], s3 offen offset:0 sc1 lds
    buffer_load_dwordx4 v8, s[28:31], s3 offen offset:1024 sc1 lds
    buffer_load_dwordx4 v8, s[28:31], s3 offen offset:2048 sc1 lds
    buffer_load_dwordx4 v8, s[28:31], s3 offen offset:3072 sc1 lds
    s_mov_b32 s3, 3
    s_and_b32 s3, s3, 7
    s_lshl_b32 s3, s3, 15
    s_add_u32 s3, s3, s38
    s_add_u32 m0, s39, 0
    s_add_u32 s3, s3, 0
    buffer_load_dwordx4 v8, s[28:31], s3 offen offset:0 sc1 lds
    buffer_load_dwordx4 v8, s[28:31], s3 offen offset:1024 sc1 lds
    buffer_load_dwordx4 v8, s[28:31], s3 offen offset:2048 sc1 lds
    buffer_load_dwordx4 v8, s[28:31], s3 offen offset:3072 sc1 lds
    s_add_u32 m0, s39, 4096
    s_add_u32 s3, s3, 4096
    buffer_load_dwordx4 v8, s[28:31], s3 offen offset:0 sc1 lds
    buffer_load_dwordx4 v8, s[28:31], s3 offen offset:1024 sc1 lds
    buffer_load_dwordx4 v8, s[28:31], s3 offen offset:2048 sc1 lds
    buffer_load_dwordx4 v8, s[28:31], s3 offen offset:3072 sc1 lds
    s_waitcnt vmcnt(8)
    s_barrier
    s_mov_b32 s3, 4
    s_and_b32 s3, s3, 7
    s_lshl_b32 s3, s3, 15
    s_add_u32 s3, s3, s38
    s_add_u32 m0, s39, 32768
    s_add_u32 s3, s3, 0
    buffer_load_dwordx4 v8, s[28:31], s3 offen offset:0 sc1 lds
    buffer_load_dwordx4 v8, s[28:31], s3 offen offset:1024 sc1 lds
    buffer_load_dwordx4 v8, s[28:31], s3 offen offset:2048 sc1 lds
    buffer_load_dwordx4 v8, s[28:31], s3 offen offset:3072 sc1 lds
    s_add_u32 m0, s39, 36864
    s_add_u32 s3, s3, 4096
    buffer_load_dwordx4 v8, s[28:31], s3 offen offset:0 sc1 lds
    buffer_load_dwordx4 v8, s[28:31], s3 offen offset:1024 sc1 lds
    buffer_load_dwordx4 v8, s[28:31], s3 offen offset:2048 sc1 lds
    buffer_load_dwordx4 v8, s[28:31], s3 offen offset:3072 sc1 lds
    s_mov_b32 s69, 0x40000
POLL_25:
    buffer_load_dwordx2 v[16:17], v3, s[28:31], s61 offen sc1
    s_waitcnt vmcnt(0)
    v_cmp_eq_u64 vcc, s[50:51], v[16:17]
    s_sub_u32 s69, s69, 1
    s_cbranch_scc1 POLLD_26
    s_cmp_eq_u64 vcc, -1
    s_cbranch_scc1 POLLD_26
    s_sleep 4
    s_branch POLL_25
POLLD_26:
    s_barrier
    s_mov_b32 s3, 5
    s_and_b32 s3, s3, 7
    s_lshl_b32 s3, s3, 15
    s_add_u32 s3, s3, s38
    s_add_u32 m0, s39, 65536
    s_add_u32 s3, s3, 0
    buffer_load_dwordx4 v8, s[28:31], s3 offen offset:0 sc1 lds
    buffer_load_dwordx4 v8, s[28:31], s3 offen offset:1024 sc1 lds
    buffer_load_dwordx4 v8, s[28:31], s3 offen offset:2048 sc1 lds
    buffer_load_dwordx4 v8, s[28:31], s3 offen offset:3072 sc1 lds
    s_add_u32 m0, s39, 69632
    s_add_u32 s3, s3, 4096
    buffer_load_dwordx4 v8, s[28:31], s3 offen offset:0 sc1 lds
    buffer_load_dwordx4 v8, s[28:31], s3 offen offset:1024 sc1 lds
    buffer_load_dwordx4 v8, s[28:31], s3 offen offset:2048 sc1 lds
    buffer_load_dwordx4 v8, s[28:31], s3 offen offset:3072 sc1 lds
    s_barrier
    s_mov_b32 s3, 6
    s_and_b32 s3, s3, 7
    s_lshl_b32 s3, s3, 15
    s_add_u32 s3, s3, s38
    s_add_u32 m0, s39, 0
    s_add_u32 s3, s3, 0
    buffer_load_dwordx4 v8, s[28:31], s3 offen offset:0 sc1 lds
    buffer_load_dwordx4 v8, s[28:31], s3 offen offset:1024 sc1 lds
    buffer_load_dwordx4 v8, s[28:31], s3 offen offset:2048 sc1 lds
    buffer_load_dwordx4 v8, s[28:31], s3 offen offset:3072 sc1 lds
    s_add_u32 m0, s39, 4096
    s_add_u32 s3, s3, 4096
    buffer_load_dwordx4 v8, s[28:31], s3 offen offset:0 sc1 lds
    buffer_load_dwordx4 v8, s[28:31], s3 offen offset:1024 sc1 lds
    buffer_load_dwordx4 v8, s[28:31], s3 offen offset:2048 sc1 lds
    buffer_load_dwordx4 v8, s[28:31], s3 offen offset:3072 sc1 lds
    s_waitcnt vmcnt(8)
    s_barrier
    s_mov_b32 s3, 7
    s_and_b32 s3, s3, 7
    s_lshl_b32 s3, s3, 15
    s_add_u32 s3, s3, s38
    s_add_u32 m0, s39, 32768
    s_add_u32 s3, s3, 0
    buffer_load_dwordx4 v8, s[28:31], s3 offen offset:0 sc1 lds
    buffer_load_dwordx4 v8, s[28:31], s3 offen offset:1024 sc1 lds
    buffer_load_dwordx4 v8, s[28:31], s3 offen offset:2048 sc1 lds
    buffer_load_dwordx4 v8, s[28:31], s3 offen offset:3072 sc1 lds
    s_add_u32 m0, s39, 36864
    s_add_u32 s3, s3, 4096
    buffer_load_dwordx4 v8, s[28:31], s3 offen offset:0 sc1 lds
    buffer_load_dwordx4 v8, s[28:31], s3 offen offset:1024 sc1 lds
    buffer_load_dwordx4 v8, s[28:31], s3 offen offset:2048 sc1 lds
    buffer_load_dwordx4 v8, s[28:31], s3 offen offset:3072 sc1 lds
    s_waitcnt vmcnt(8)
    s_barrier
    s_waitcnt vmcnt(0)
    s_barrier
L_END:
    s_endpgm
L_COMPUTE:
    s_and_b32 s49, s26, 3
    s_lshr_b32 s62, s26, 2
    s_lshl_b32 s61, s49, 12
    v_and_b32 v2, 31, v1
    v_lshrrev_b32 v3, 5, v1
    v_bfe_u32 v4, v1, 1, 3
    v_lshlrev_b32 v5, 7, v2
    v_add_u32 v5, s61, v5
    v_cmp_eq_u32 s[54:55], 28, v2
    v_cmp_le_u32 s[46:47], 28, v2
    v_add_u32 v6, 0, v3
    v_xor_b32 v6, v6, v4
    v_lshl_add_u32 v10, v6, 4, v5
    v_add_u32 v14, 65536, v10
    v_add_u32 v6, 2, v3
    v_xor_b32 v6, v6, v4
    v_lshl_add_u32 v11, v6, 4, v5
    v_add_u32 v15, 65536, v11
    v_add_u32 v6, 4, v3
    v_xor_b32 v6, v6, v4
    v_lshl_add_u32 v12, v6, 4, v5
    v_add_u32 v16, 65536, v12
    v_add_u32 v6, 6, v3
    v_xor_b32 v6, v6, v4
    v_lshl_add_u32 v13, v6, 4, v5
    v_add_u32 v17, 65536, v13
    v_bfe_u32 v4, v1, 4, 1
    v_bfe_u32 v5, v1, 2, 2
    v_and_b32 v6, 3, v1
    v_lshlrev_b32 v6, 3, v6
    v_lshl_add_u32 v8, v3, 9, v6
    v_lshl_add_u32 v8, v5, 6, v8
    v_lshl_add_u32 v8, v4, 5, v8
    s_lshl_b32 s61, s62, 13
    s_add_u32 s61, s61, 114688
    v_add_u32 v18, s61, v8
    v_lshl_add_u32 v7, v3, 10, v6
    v_lshl_add_u32 v7, v5, 7, v7
    v_lshl_add_u32 v7, v4, 13, v7
    s_lshl_b32 s61, s62, 12
    v_add_u32 v7, s61, v7
    v_and_b32 v5, 2, v5
    v_xor_b32 v5, v5, v4
    s_and_b32 s63, s26, 2
    v_xor_b32 v5, s63, v5
    v_lshl_add_u32 v19, v5, 5, v7
    v_xor_b32 v5, 1, v5
    v_lshl_add_u32 v20, v5, 5, v7
    v_add_u32 v21, 114688, v19
    v_add_u32 v22, 114688, v20
    s_waitcnt lgkmcnt(0)
    s_mov_b32 s28, s24
    s_and_b32 s29, s25, 0xffff
    s_mov_b32 s30, 25165824
    s_mov_b32 s31, 0x20000
    v_mov_b32 v152, 0
    s_lshl_b32 s3, s2, 4
    s_add_u32 s3, s3, s26
    s_cmp_lg_u32 s3, 7
    s_cbranch_scc1 NSKIP_27
    s_memrealtime s[50:51]
    s_waitcnt lgkmcnt(0)
    s_mul_i32 s44, s51, 0x7f4a7c15
    s_mul_i32 s45, s50, 0x9e3779b9
    s_mul_hi_u32 s51, s50, 0x7f4a7c15
    s_mul_i32 s50, s50, 0x7f4a7c15
    s_add_u32 s51, s51, s44
    s_add_u32 s51, s51, s45
    s_xor_b32 s50, s50, s51
    s_or_b32 s50, s50, 1
    v_mov_b32 v154, s50
    v_mov_b32 v155, s51
    s_mov_b64 exec, 1
    global_store_dwordx2 v152, v[154:155], s[22:23] sc0 sc1
    s_mov_b64 exec, -1
NSKIP_27:
    s_lshl_b32 s60, s62, 1
    s_add_u32 s60, s60, s59
    s_lshl_b32 s64, s56, 2
    s_add_u32 s64, s64, s49
    s_and_b32 s43, s26, 1
    s_lshl_b32 s43, s43, 13
    s_lshl_b32 s61, s49, 12
    s_sub_u32 s43, s43, s61
    v_and_b32 v2, 31, v1
    v_cmp_lt_u32 vcc, 10, v2
    v_mov_b32 v3, v2
    v_lshrrev_b32 v5, 5, v1
    v_addc_co_u32 v3, vcc, 0, v3, vcc
    v_cmp_lt_u32 vcc, 13, v2
    v_and_b32 v6, 1, v2
    v_and_b32 v7, 2, v2
    v_addc_co_u32 v3, vcc, 0, v3, vcc
    v_cmp_lt_u32 vcc, 24, v2
    v_lshlrev_b32 v6, 2, v6
    v_lshl_add_u32 v6, v7, 3, v6
    v_addc_co_u32 v3, vcc, 0, v3, vcc
    v_add_u32 v6, 11, v6
    v_cmp_lt_u32 vcc, 27, v2
    s_nop 1
    v_cndmask_b32 v3, v3, v6, vcc
    v_lshl_add_u32 v3, v5, 5, v3
    v_lshlrev_b32 v3, 4, v3
    s_cmp_ge_u32 s60, 32
    s_cselect_b64 vcc, -1, 0
    s_nop 0
    v_cndmask_b32 v23, v9, v3, vcc
    s_add_u32 s66, s60, 0
    s_mul_i32 s44, s66, 4352
    s_lshl_b32 s3, s64, 3
    s_add_u32 s44, s44, s3
    s_add_u32 s44, s44, 22298624
    s_and_b32 s45, s66, 15
    s_lshl_b32 s45, s45, 2
    s_bfe_u32 s3, s64, 0x20001
    s_add_u32 s45, s45, s3
    s_mul_i32 s45, s45, 4352
    s_lshr_b32 s3, s66, 5
    s_lshl_b32 s3, s3, 3
    s_lshr_b32 s61, s64, 3
    s_add_u32 s3, s3, s61
    s_lshl_b32 s3, s3, 1
    s_and_b32 s61, s64, 1
    s_add_u32 s3, s3, s61
    s_lshl_b32 s3, s3, 3
    s_add_u32 s45, s45, s3
    s_add_u32 s45, s45, 22020096
    s_cmp_lt_u32 s66, 16
    s_cselect_b32 s40, s44, s45
    s_and_b32 s61, s66, 15
    s_lshl_b32 s61, s61, 6
    s_add_u32 s61, s61, s64
    s_cmp_lt_u32 s66, 16
    s_cselect_b32 s32, 0x3e8b97f6, 1.0
    s_mov_b32 s33, s32
    s_cselect_b32 s36, 0, 0x3f80
    s_cselect_b32 s3, 11, 12
    s_cselect_b32 s44, 0, 2097152
    s_lshl_b32 s61, s61, s3
    s_add_u32 s38, s61, s44
    s_add_u32 s66, s60, 1
    s_mul_i32 s44, s66, 4352
    s_lshl_b32 s3, s64, 3
    s_add_u32 s44, s44, s3
    s_add_u32 s44, s44, 22298624
    s_and_b32 s45, s66, 15
    s_lshl_b32 s45, s45, 2
    s_bfe_u32 s3, s64, 0x20001
    s_add_u32 s45, s45, s3
    s_mul_i32 s45, s45, 4352
    s_lshr_b32 s3, s66, 5
    s_lshl_b32 s3, s3, 3
    s_lshr_b32 s61, s64, 3
    s_add_u32 s3, s3, s61
    s_lshl_b32 s3, s3, 1
    s_and_b32 s61, s64, 1
    s_add_u32 s3, s3, s61
    s_lshl_b32 s3, s3, 3
    s_add_u32 s45, s45, s3
    s_add_u32 s45, s45, 22020096
    s_cmp_lt_u32 s66, 16
    s_cselect_b32 s41, s44, s45
    s_and_b32 s61, s66, 15
    s_lshl_b32 s61, s61, 6
    s_add_u32 s61, s61, s64
    s_cmp_lt_u32 s66, 16
    s_cselect_b32 s34, 0x3e8b97f6, 1.0
    s_mov_b32 s35, s34
    s_cselect_b32 s37, 0, 0x3f80
    s_cselect_b32 s3, 11, 12
    s_cselect_b32 s44, 0, 2097152
    s_lshl_b32 s61, s61, s3
    s_add_u32 s39, s61, s44
    s_cmp_ge_u32 s26, 4
    s_cselect_b32 s41, s40, s41
    s_cbranch_scc1 P1_Y
    s_cmp_ge_u32 s60, 32
    s_cbranch_scc1 P1_XV
P1_XN:
    s_barrier
    ds_read_b128 v[24:27], v10 offset:0
    ds_read_b64_tr_b16 v[40:41], v18 offset:0
    ds_read_b64_tr_b16 v[42:43], v18 offset:256
    ds_read_b64_tr_b16 v[44:45], v18 offset:4096
    ds_read_b64_tr_b16 v[46:47], v18 offset:4352
    s_waitcnt lgkmcnt(0)
    ds_read_b128 v[32:35], v11 offset:0
    ds_read_b64_tr_b16 v[48:49], v18 offset:1024
    ds_read_b64_tr_b16 v[50:51], v18 offset:1280
    ds_read_b64_tr_b16 v[52:53], v18 offset:5120
    ds_read_b64_tr_b16 v[54:55], v18 offset:5376
    v_mfma_f32_32x32x16_bf16 v[56:71], v[40:43], v[24:27], 0
    v_mfma_f32_32x32x16_bf16 v[72:87], v[44:47], v[24:27], 0
    s_waitcnt lgkmcnt(0)
    ds_read_b128 v[24:27], v12 offset:0
    ds_read_b64_tr_b16 v[40:41], v18 offset:2048
    ds_read_b64_tr_b16 v[42:43], v18 offset:2304
    ds_read_b64_tr_b16 v[44:45], v18 offset:6144
    ds_read_b64_tr_b16 v[46:47], v18 offset:6400
    v_mfma_f32_32x32x16_bf16 v[56:71], v[48:51], v[32:35], v[56:71]
    v_mfma_f32_32x32x16_bf16 v[72:87], v[52:55], v[32:35], v[72:87]
    s_waitcnt lgkmcnt(0)
    ds_read_b128 v[32:35], v13 offset:0
    ds_read_b64_tr_b16 v[48:49], v18 offset:3072
    ds_read_b64_tr_b16 v[50:51], v18 offset:3328
    ds_read_b64_tr_b16 v[52:53], v18 offset:7168
    ds_read_b64_tr_b16 v[54:55], v18 offset:7424
    v_mfma_f32_32x32x16_bf16 v[56:71], v[40:43], v[24:27], v[56:71]
    v_mfma_f32_32x32x16_bf16 v[72:87], v[44:47], v[24:27], v[72:87]
    s_waitcnt lgkmcnt(0)
    s_barrier
    ds_read_b128 v[24:27], v10 offset:16384
    ds_read_b64_tr_b16 v[40:41], v18 offset:16384
    ds_read_b64_tr_b16 v[42:43], v18 offset:16640
    ds_read_b64_tr_b16 v[44:45], v18 offset:20480
    ds_read_b64_tr_b16 v[46:47], v18 offset:20736
    v_mfma_f32_32x32x16_bf16 v[56:71], v[48:51], v[32:35], v[56:71]
    v_mfma_f32_32x32x16_bf16 v[72:87], v[52:55], v[32:35], v[72:87]
    s_waitcnt lgkmcnt(0)
    ds_read_b128 v[32:35], v11 offset:16384
    ds_read_b64_tr_b16 v[48:49], v18 offset:17408
    ds_read_b64_tr_b16 v[50:51], v18 offset:17664
    ds_read_b64_tr_b16 v[52:53], v18 offset:21504
    ds_read_b64_tr_b16 v[54:55], v18 offset:21760
    v_mfma_f32_32x32x16_bf16 v[56:71], v[40:43], v[24:27], v[56:71]
    v_mfma_f32_32x32x16_bf16 v[72:87], v[44:47], v[24:27], v[72:87]
    s_waitcnt lgkmcnt(0)
    ds_read_b128 v[24:27], v12 offset:16384
    ds_read_b64_tr_b16 v[40:41], v18 offset:18432
    ds_read_b64_tr_b16 v[42:43], v18 offset:18688
    ds_read_b64_tr_b16 v[44:45], v18 offset:22528
    ds_read_b64_tr_b16 v[46:47], v18 offset:22784
    v_mfma_f32_32x32x16_bf16 v[56:71], v[48:51], v[32:35], v[56:71]
    v_mfma_f32_32x32x16_bf16 v[72:87], v[52:55], v[32:35], v[72:87]
    s_waitcnt lgkmcnt(0)
    ds_read_b128 v[32:35], v13 offset:16384
    ds_read_b64_tr_b16 v[48:49], v18 offset:19456
    ds_read_b64_tr_b16 v[50:51], v18 offset:19712
    ds_read_b64_tr_b16 v[52:53], v18 offset:23552
    ds_read_b64_tr_b16 v[54:55], v18 offset:23808
    v_mfma_f32_32x32x16_bf16 v[56:71], v[40:43], v[24:27], v[56:71]
    v_mfma_f32_32x32x16_bf16 v[72:87], v[44:47], v[24:27], v[72:87]
    s_waitcnt lgkmcnt(0)
    s_barrier
    ds_read_b128 v[24:27], v10 offset:32768
    ds_read_b64_tr_b16 v[40:41], v18 offset:32768
    ds_read_b64_tr_b16 v[42:43], v18 offset:33024
    ds_read_b64_tr_b16 v[44:45], v18 offset:36864
    ds_read_b64_tr_b16 v[46:47], v18 offset:37120
    v_mfma_f32_32x32x16_bf16 v[56:71], v[48:51], v[32:35], v[56:71]
    v_mfma_f32_32x32x16_bf16 v[72:87], v[52:55], v[32:35], v[72:87]
    s_waitcnt lgkmcnt(0)
    ds_read_b128 v[32:35], v11 offset:32768
    ds_read_b64_tr_b16 v[48:49], v18 offset:33792
    ds_read_b64_tr_b16 v[50:51], v18 offset:34048
    ds_read_b64_tr_b16 v[52:53], v18 offset:37888
    ds_read_b64_tr_b16 v[54:55], v18 offset:38144
    v_mfma_f32_32x32x16_bf16 v[56:71], v[40:43], v[24:27], v[56:71]
    v_mfma_f32_32x32x16_bf16 v[72:87], v[44:47], v[24:27], v[72:87]
    s_waitcnt lgkmcnt(0)
    ds_read_b128 v[24:27], v12 offset:32768
    ds_read_b64_tr_b16 v[40:41], v18 offset:34816
    ds_read_b64_tr_b16 v[42:43], v18 offset:35072
    ds_read_b64_tr_b16 v[44:45], v18 offset:38912
    ds_read_b64_tr_b16 v[46:47], v18 offset:39168
    v_mfma_f32_32x32x16_bf16 v[56:71], v[48:51], v[32:35], v[56:71]
    v_mfma_f32_32x32x16_bf16 v[72:87], v[52:55], v[32:35], v[72:87]
    s_waitcnt lgkmcnt(0)
    ds_read_b128 v[32:35], v13 offset:32768
    ds_read_b64_tr_b16 v[48:49], v18 offset:35840
    ds_read_b64_tr_b16 v[50:51], v18 offset:36096
    ds_read_b64_tr_b16 v[52:53], v18 offset:39936
    ds_read_b64_tr_b16 v[54:55], v18 offset:40192
    v_mfma_f32_32x32x16_bf16 v[56:71], v[40:43], v[24:27], v[56:71]
    v_mfma_f32_32x32x16_bf16 v[72:87], v[44:47], v[24:27], v[72:87]
    s_waitcnt lgkmcnt(0)
    s_barrier
    ds_read_b128 v[24:27], v10 offset:49152
    ds_read_b64_tr_b16 v[40:41], v18 offset:0
    ds_read_b64_tr_b16 v[42:43], v18 offset:256
    ds_read_b64_tr_b16 v[44:45], v18 offset:4096
    ds_read_b64_tr_b16 v[46:47], v18 offset:4352
    v_mfma_f32_32x32x16_bf16 v[56:71], v[48:51], v[32:35], v[56:71]
    v_mfma_f32_32x32x16_bf16 v[72:87], v[52:55], v[32:35], v[72:87]
    s_waitcnt lgkmcnt(0)
    ds_read_b128 v[32:35], v11 offset:49152
    ds_read_b64_tr_b16 v[48:49], v18 offset:1024
    ds_read_b64_tr_b16 v[50:51], v18 offset:1280
    ds_read_b64_tr_b16 v[52:53], v18 offset:5120
    ds_read_b64_tr_b16 v[54:55], v18 offset:5376
    v_mfma_f32_32x32x16_bf16 v[56:71], v[40:43], v[24:27], v[56:71]
    v_mfma_f32_32x32x16_bf16 v[72:87], v[44:47], v[24:27], v[72:87]
    s_waitcnt lgkmcnt(0)
    ds_read_b128 v[24:27], v12 offset:49152
    ds_read_b64_tr_b16 v[40:41], v18 offset:2048
    ds_read_b64_tr_b16 v[42:43], v18 offset:2304
    ds_read_b64_tr_b16 v[44:45], v18 offset:6144
    ds_read_b64_tr_b16 v[46:47], v18 offset:6400
    v_mfma_f32_32x32x16_bf16 v[56:71], v[48:51], v[32:35], v[56:71]
    v_mfma_f32_32x32x16_bf16 v[72:87], v[52:55], v[32:35], v[72:87]
    s_waitcnt lgkmcnt(0)
    ds_read_b128 v[32:35], v13 offset:49152
    ds_read_b64_tr_b16 v[48:49], v18 offset:3072
    ds_read_b64_tr_b16 v[50:51], v18 offset:3328
    ds_read_b64_tr_b16 v[52:53], v18 offset:7168
    ds_read_b64_tr_b16 v[54:55], v18 offset:7424
    v_mfma_f32_32x32x16_bf16 v[56:71], v[40:43], v[24:27], v[56:71]
    v_mfma_f32_32x32x16_bf16 v[72:87], v[44:47], v[24:27], v[72:87]
    s_waitcnt lgkmcnt(0)
    s_barrier
    ds_read_b128 v[24:27], v14 offset:0
    ds_read_b64_tr_b16 v[40:41], v18 offset:16384
    ds_read_b64_tr_b16 v[42:43], v18 offset:16640
    ds_read_b64_tr_b16 v[44:45], v18 offset:20480
    ds_read_b64_tr_b16 v[46:47], v18 offset:20736
    v_mfma_f32_32x32x16_bf16 v[56:71], v[48:51], v[32:35], v[56:71]
    v_mfma_f32_32x32x16_bf16 v[72:87], v[52:55], v[32:35], v[72:87]
    s_waitcnt lgkmcnt(0)
    ds_read_b128 v[32:35], v15 offset:0
    ds_read_b64_tr_b16 v[48:49], v18 offset:17408
    ds_read_b64_tr_b16 v[50:51], v18 offset:17664
    ds_read_b64_tr_b16 v[52:53], v18 offset:21504
    ds_read_b64_tr_b16 v[54:55], v18 offset:21760
    v_mfma_f32_32x32x16_bf16 v[56:71], v[40:43], v[24:27], v[56:71]
    v_mfma_f32_32x32x16_bf16 v[72:87], v[44:47], v[24:27], v[72:87]
    s_waitcnt lgkmcnt(0)
    ds_read_b128 v[24:27], v16 offset:0
    ds_read_b64_tr_b16 v[40:41], v18 offset:18432
    ds_read_b64_tr_b16 v[42:43], v18 offset:18688
    ds_read_b64_tr_b16 v[44:45], v18 offset:22528
    ds_read_b64_tr_b16 v[46:47], v18 offset:22784
    v_mfma_f32_32x32x16_bf16 v[56:71], v[48:51], v[32:35], v[56:71]
    v_mfma_f32_32x32x16_bf16 v[72:87], v[52:55], v[32:35], v[72:87]
    s_waitcnt lgkmcnt(0)
    ds_read_b128 v[32:35], v17 offset:0
    ds_read_b64_tr_b16 v[48:49], v18 offset:19456
    ds_read_b64_tr_b16 v[50:51], v18 offset:19712
    ds_read_b64_tr_b16 v[52:53], v18 offset:23552
    ds_read_b64_tr_b16 v[54:55], v18 offset:23808
    v_mfma_f32_32x32x16_bf16 v[56:71], v[40:43], v[24:27], v[56:71]
    v_mfma_f32_32x32x16_bf16 v[72:87], v[44:47], v[24:27], v[72:87]
    s_waitcnt lgkmcnt(0)
    s_barrier
    ds_read_b128 v[24:27], v14 offset:16384
    ds_read_b64_tr_b16 v[40:41], v18 offset:32768
    ds_read_b64_tr_b16 v[42:43], v18 offset:33024
    ds_read_b64_tr_b16 v[44:45], v18 offset:36864
    ds_read_b64_tr_b16 v[46:47], v18 offset:37120
    v_mfma_f32_32x32x16_bf16 v[56:71], v[48:51], v[32:35], v[56:71]
    v_mfma_f32_32x32x16_bf16 v[72:87], v[52:55], v[32:35], v[72:87]
    s_waitcnt lgkmcnt(0)
    ds_read_b128 v[32:35], v15 offset:16384
    ds_read_b64_tr_b16 v[48:49], v18 offset:33792
    ds_read_b64_tr_b16 v[50:51], v18 offset:34048
    ds_read_b64_tr_b16 v[52:53], v18 offset:37888
    ds_read_b64_tr_b16 v[54:55], v18 offset:38144
    v_mfma_f32_32x32x16_bf16 v[56:71], v[40:43], v[24:27], v[56:71]
    v_mfma_f32_32x32x16_bf16 v[72:87], v[44:47], v[24:27], v[72:87]
    s_waitcnt lgkmcnt(0)
    ds_read_b128 v[24:27], v16 offset:16384
    ds_read_b64_tr_b16 v[40:41], v18 offset:34816
    ds_read_b64_tr_b16 v[42:43], v18 offset:35072
    ds_read_b64_tr_b16 v[44:45], v18 offset:38912
    ds_read_b64_tr_b16 v[46:47], v18 offset:39168
    v_mfma_f32_32x32x16_bf16 v[56:71], v[48:51], v[32:35], v[56:71]
    v_mfma_f32_32x32x16_bf16 v[72:87], v[52:55], v[32:35], v[72:87]
    s_waitcnt lgkmcnt(0)
    ds_read_b128 v[32:35], v17 offset:16384
    ds_read_b64_tr_b16 v[48:49], v18 offset:35840
    ds_read_b64_tr_b16 v[50:51], v18 offset:36096
    ds_read_b64_tr_b16 v[52:53], v18 offset:39936
    ds_read_b64_tr_b16 v[54:55], v18 offset:40192
    v_mfma_f32_32x32x16_bf16 v[56:71], v[40:43], v[24:27], v[56:71]
    v_mfma_f32_32x32x16_bf16 v[72:87], v[44:47], v[24:27], v[72:87]
    s_waitcnt lgkmcnt(0)
    s_barrier
    ds_read_b128 v[24:27], v14 offset:32768
    ds_read_b64_tr_b16 v[40:41], v18 offset:0
    ds_read_b64_tr_b16 v[42:43], v18 offset:256
    ds_read_b64_tr_b16 v[44:45], v18 offset:4096
    ds_read_b64_tr_b16 v[46:47], v18 offset:4352
    v_mfma_f32_32x32x16_bf16 v[56:71], v[48:51], v[32:35], v[56:71]
    v_mfma_f32_32x32x16_bf16 v[72:87], v[52:55], v[32:35], v[72:87]
    s_waitcnt lgkmcnt(0)
    ds_read_b128 v[32:35], v15 offset:32768
    ds_read_b64_tr_b16 v[48:49], v18 offset:1024
    ds_read_b64_tr_b16 v[50:51], v18 offset:1280
    ds_read_b64_tr_b16 v[52:53], v18 offset:5120
    ds_read_b64_tr_b16 v[54:55], v18 offset:5376
    v_mfma_f32_32x32x16_bf16 v[56:71], v[40:43], v[24:27], v[56:71]
    v_mfma_f32_32x32x16_bf16 v[72:87], v[44:47], v[24:27], v[72:87]
    s_waitcnt lgkmcnt(0)
    ds_read_b128 v[24:27], v16 offset:32768
    ds_read_b64_tr_b16 v[40:41], v18 offset:2048
    ds_read_b64_tr_b16 v[42:43], v18 offset:2304
    ds_read_b64_tr_b16 v[44:45], v18 offset:6144
    ds_read_b64_tr_b16 v[46:47], v18 offset:6400
    v_mfma_f32_32x32x16_bf16 v[56:71], v[48:51], v[32:35], v[56:71]
    v_mfma_f32_32x32x16_bf16 v[72:87], v[52:55], v[32:35], v[72:87]
    s_waitcnt lgkmcnt(0)
    ds_read_b128 v[32:35], v17 offset:32768
    ds_read_b64_tr_b16 v[48:49], v18 offset:3072
    ds_read_b64_tr_b16 v[50:51], v18 offset:3328
    ds_read_b64_tr_b16 v[52:53], v18 offset:7168
    ds_read_b64_tr_b16 v[54:55], v18 offset:7424
    v_mfma_f32_32x32x16_bf16 v[56:71], v[40:43], v[24:27], v[56:71]
    v_mfma_f32_32x32x16_bf16 v[72:87], v[44:47], v[24:27], v[72:87]
    s_waitcnt lgkmcnt(0)
    v_mfma_f32_32x32x16_bf16 v[56:71], v[48:51], v[32:35], v[56:71]
    v_mfma_f32_32x32x16_bf16 v[72:87], v[52:55], v[32:35], v[72:87]
    global_load_dwordx2 v[164:165], v152, s[22:23] sc1
    s_barrier
    v_add_u32 v10, s43, v10
    v_add_u32 v11, s43, v11
    v_add_u32 v12, s43, v12
    v_add_u32 v13, s43, v13
    v_add_u32 v14, s43, v14
    v_add_u32 v15, s43, v15
    v_add_u32 v16, s43, v16
    v_add_u32 v17, s43, v17
    ds_read_b128 v[24:27], v10 offset:0
    ds_read_b128 v[28:31], v10 offset:4096
    ds_read_b64_tr_b16 v[40:41], v21 offset:16384
    ds_read_b64_tr_b16 v[42:43], v21 offset:16896
    ds_read_b64_tr_b16 v[44:45], v22 offset:16384
    ds_read_b64_tr_b16 v[46:47], v22 offset:16896
    v_mul_f32 v56, s32, v56
    v_mul_f32 v57, s32, v57
    v_mul_f32 v58, s32, v58
    v_mul_f32 v59, s32, v59
    v_mul_f32 v60, s32, v60
    v_mul_f32 v61, s32, v61
    v_mul_f32 v62, s32, v62
    v_mul_f32 v63, s32, v63
    v_mul_f32 v64, s32, v64
    v_mul_f32 v65, s32, v65
    v_mul_f32 v66, s32, v66
    v_mul_f32 v67, s32, v67
    v_mul_f32 v68, s32, v68
    v_mul_f32 v69, s32, v69
    v_mul_f32 v70, s32, v70
    v_mul_f32 v71, s32, v71
    v_mov_b32 v144, s36
    v_cvt_pk_bf16_f32 v56, v56, v57
    v_cvt_pk_bf16_f32 v57, v58, v59
    v_cvt_pk_bf16_f32 v58, v60, v61
    v_cvt_pk_bf16_f32 v59, v62, v63
    v_cvt_pk_bf16_f32 v60, v64, v65
    v_cvt_pk_bf16_f32 v61, v66, v67
    v_cvt_pk_bf16_f32 v62, v68, v69
    v_cvt_pk_bf16_f32 v63, v70, v71
    v_cndmask_b32 v62, v62, v144, s[52:53]
    v_cndmask_b32 v63, v63, 0, s[52:53]
    v_mul_f32 v72, s34, v72
    v_mul_f32 v73, s34, v73
    v_mul_f32 v74, s34, v74
    v_mul_f32 v75, s34, v75
    v_mul_f32 v76, s34, v76
    v_mul_f32 v77, s34, v77
    v_mul_f32 v78, s34, v78
    v_mul_f32 v79, s34, v79
    v_mul_f32 v80, s34, v80
    v_mul_f32 v81, s34, v81
    v_mul_f32 v82, s34, v82
    v_mul_f32 v83, s34, v83
    v_mul_f32 v84, s34, v84
    v_mul_f32 v85, s34, v85
    v_mul_f32 v86, s34, v86
    v_mul_f32 v87, s34, v87
    v_mov_b32 v144, s37
    v_cvt_pk_bf16_f32 v72, v72, v73
    v_cvt_pk_bf16_f32 v73, v74, v75
    v_cvt_pk_bf16_f32 v74, v76, v77
    v_cvt_pk_bf16_f32 v75, v78, v79
    v_cvt_pk_bf16_f32 v76, v80, v81
    v_cvt_pk_bf16_f32 v77, v82, v83
    v_cvt_pk_bf16_f32 v78, v84, v85
    v_cvt_pk_bf16_f32 v79, v86, v87
    v_cndmask_b32 v78, v78, v144, s[52:53]
    v_cndmask_b32 v79, v79, 0, s[52:53]
    s_branch P2_START
P1_XV:
    s_barrier
    ds_read_b128 v[24:27], v10 offset:0
    ds_read_b64_tr_b16 v[40:41], v18 offset:0
    ds_read_b64_tr_b16 v[42:43], v18 offset:256
    ds_read_b64_tr_b16 v[44:45], v18 offset:4096
    ds_read_b64_tr_b16 v[46:47], v18 offset:4352
    s_waitcnt lgkmcnt(0)
    ds_read_b128 v[32:35], v11 offset:0
    ds_read_b64_tr_b16 v[48:49], v18 offset:1024
    ds_read_b64_tr_b16 v[50:51], v18 offset:1280
    ds_read_b64_tr_b16 v[52:53], v18 offset:5120
    ds_read_b64_tr_b16 v[54:55], v18 offset:5376
    v_mfma_f32_32x32x16_bf16 v[56:71], v[24:27], v[40:43], 0
    v_mfma_f32_32x32x16_bf16 v[72:87], v[24:27], v[44:47], 0
    s_waitcnt lgkmcnt(0)
    ds_read_b128 v[24:27], v12 offset:0
    ds_read_b64_tr_b16 v[40:41], v18 offset:2048
    ds_read_b64_tr_b16 v[42:43], v18 offset:2304
    ds_read_b64_tr_b16 v[44:45], v18 offset:6144
    ds_read_b64_tr_b16 v[46:47], v18 offset:6400
    v_mfma_f32_32x32x16_bf16 v[56:71], v[32:35], v[48:51], v[56:71]
    v_mfma_f32_32x32x16_bf16 v[72:87], v[32:35], v[52:55], v[72:87]
    s_waitcnt lgkmcnt(0)
    ds_read_b128 v[32:35], v13 offset:0
    ds_read_b64_tr_b16 v[48:49], v18 offset:3072
    ds_read_b64_tr_b16 v[50:51], v18 offset:3328
    ds_read_b64_tr_b16 v[52:53], v18 offset:7168
    ds_read_b64_tr_b16 v[54:55], v18 offset:7424
    v_mfma_f32_32x32x16_bf16 v[56:71], v[24:27], v[40:43], v[56:71]
    v_mfma_f32_32x32x16_bf16 v[72:87], v[24:27], v[44:47], v[72:87]
    s_waitcnt lgkmcnt(0)
    s_barrier
    ds_read_b128 v[24:27], v10 offset:16384
    ds_read_b64_tr_b16 v[40:41], v18 offset:16384
    ds_read_b64_tr_b16 v[42:43], v18 offset:16640
    ds_read_b64_tr_b16 v[44:45], v18 offset:20480
    ds_read_b64_tr_b16 v[46:47], v18 offset:20736
    v_mfma_f32_32x32x16_bf16 v[56:71], v[32:35], v[48:51], v[56:71]
    v_mfma_f32_32x32x16_bf16 v[72:87], v[32:35], v[52:55], v[72:87]
    s_waitcnt lgkmcnt(0)
    ds_read_b128 v[32:35], v11 offset:16384
    ds_read_b64_tr_b16 v[48:49], v18 offset:17408
    ds_read_b64_tr_b16 v[50:51], v18 offset:17664
    ds_read_b64_tr_b16 v[52:53], v18 offset:21504
    ds_read_b64_tr_b16 v[54:55], v18 offset:21760
    v_mfma_f32_32x32x16_bf16 v[56:71], v[24:27], v[40:43], v[56:71]
    v_mfma_f32_32x32x16_bf16 v[72:87], v[24:27], v[44:47], v[72:87]
    s_waitcnt lgkmcnt(0)
    ds_read_b128 v[24:27], v12 offset:16384
    ds_read_b64_tr_b16 v[40:41], v18 offset:18432
    ds_read_b64_tr_b16 v[42:43], v18 offset:18688
    ds_read_b64_tr_b16 v[44:45], v18 offset:22528
    ds_read_b64_tr_b16 v[46:47], v18 offset:22784
    v_mfma_f32_32x32x16_bf16 v[56:71], v[32:35], v[48:51], v[56:71]
    v_mfma_f32_32x32x16_bf16 v[72:87], v[32:35], v[52:55], v[72:87]
    s_waitcnt lgkmcnt(0)
    ds_read_b128 v[32:35], v13 offset:16384
    ds_read_b64_tr_b16 v[48:49], v18 offset:19456
    ds_read_b64_tr_b16 v[50:51], v18 offset:19712
    ds_read_b64_tr_b16 v[52:53], v18 offset:23552
    ds_read_b64_tr_b16 v[54:55], v18 offset:23808
    v_mfma_f32_32x32x16_bf16 v[56:71], v[24:27], v[40:43], v[56:71]
    v_mfma_f32_32x32x16_bf16 v[72:87], v[24:27], v[44:47], v[72:87]
    s_waitcnt lgkmcnt(0)
    s_barrier
    ds_read_b128 v[24:27], v10 offset:32768
    ds_read_b64_tr_b16 v[40:41], v18 offset:32768
    ds_read_b64_tr_b16 v[42:43], v18 offset:33024
    ds_read_b64_tr_b16 v[44:45], v18 offset:36864
    ds_read_b64_tr_b16 v[46:47], v18 offset:37120
    v_mfma_f32_32x32x16_bf16 v[56:71], v[32:35], v[48:51], v[56:71]
    v_mfma_f32_32x32x16_bf16 v[72:87], v[32:35], v[52:55], v[72:87]
    s_waitcnt lgkmcnt(0)
    ds_read_b128 v[32:35], v11 offset:32768
    ds_read_b64_tr_b16 v[48:49], v18 offset:33792
    ds_read_b64_tr_b16 v[50:51], v18 offset:34048
    ds_read_b64_tr_b16 v[52:53], v18 offset:37888
    ds_read_b64_tr_b16 v[54:55], v18 offset:38144
    v_mfma_f32_32x32x16_bf16 v[56:71], v[24:27], v[40:43], v[56:71]
    v_mfma_f32_32x32x16_bf16 v[72:87], v[24:27], v[44:47], v[72:87]
    s_waitcnt lgkmcnt(0)
    ds_read_b128 v[24:27], v12 offset:32768
    ds_read_b64_tr_b16 v[40:41], v18 offset:34816
    ds_read_b64_tr_b16 v[42:43], v18 offset:35072
    ds_read_b64_tr_b16 v[44:45], v18 offset:38912
    ds_read_b64_tr_b16 v[46:47], v18 offset:39168
    v_mfma_f32_32x32x16_bf16 v[56:71], v[32:35], v[48:51], v[56:71]
    v_mfma_f32_32x32x16_bf16 v[72:87], v[32:35], v[52:55], v[72:87]
    s_waitcnt lgkmcnt(0)
    ds_read_b128 v[32:35], v13 offset:32768
    ds_read_b64_tr_b16 v[48:49], v18 offset:35840
    ds_read_b64_tr_b16 v[50:51], v18 offset:36096
    ds_read_b64_tr_b16 v[52:53], v18 offset:39936
    ds_read_b64_tr_b16 v[54:55], v18 offset:40192
    v_mfma_f32_32x32x16_bf16 v[56:71], v[24:27], v[40:43], v[56:71]
    v_mfma_f32_32x32x16_bf16 v[72:87], v[24:27], v[44:47], v[72:87]
    s_waitcnt lgkmcnt(0)
    s_barrier
    ds_read_b128 v[24:27], v10 offset:49152
    ds_read_b64_tr_b16 v[40:41], v18 offset:0
    ds_read_b64_tr_b16 v[42:43], v18 offset:256
    ds_read_b64_tr_b16 v[44:45], v18 offset:4096
    ds_read_b64_tr_b16 v[46:47], v18 offset:4352
    v_mfma_f32_32x32x16_bf16 v[56:71], v[32:35], v[48:51], v[56:71]
    v_mfma_f32_32x32x16_bf16 v[72:87], v[32:35], v[52:55], v[72:87]
    s_waitcnt lgkmcnt(0)
    ds_read_b128 v[32:35], v11 offset:49152
    ds_read_b64_tr_b16 v[48:49], v18 offset:1024
    ds_read_b64_tr_b16 v[50:51], v18 offset:1280
    ds_read_b64_tr_b16 v[52:53], v18 offset:5120
    ds_read_b64_tr_b16 v[54:55], v18 offset:5376
    v_mfma_f32_32x32x16_bf16 v[56:71], v[24:27], v[40:43], v[56:71]
    v_mfma_f32_32x32x16_bf16 v[72:87], v[24:27], v[44:47], v[72:87]
    s_waitcnt lgkmcnt(0)
    ds_read_b128 v[24:27], v12 offset:49152
    ds_read_b64_tr_b16 v[40:41], v18 offset:2048
    ds_read_b64_tr_b16 v[42:43], v18 offset:2304
    ds_read_b64_tr_b16 v[44:45], v18 offset:6144
    ds_read_b64_tr_b16 v[46:47], v18 offset:6400
    v_mfma_f32_32x32x16_bf16 v[56:71], v[32:35], v[48:51], v[56:71]
    v_mfma_f32_32x32x16_bf16 v[72:87], v[32:35], v[52:55], v[72:87]
    s_waitcnt lgkmcnt(0)
    ds_read_b128 v[32:35], v13 offset:49152
    ds_read_b64_tr_b16 v[48:49], v18 offset:3072
    ds_read_b64_tr_b16 v[50:51], v18 offset:3328
    ds_read_b64_tr_b16 v[52:53], v18 offset:7168
    ds_read_b64_tr_b16 v[54:55], v18 offset:7424
    v_mfma_f32_32x32x16_bf16 v[56:71], v[24:27], v[40:43], v[56:71]
    v_mfma_f32_32x32x16_bf16 v[72:87], v[24:27], v[44:47], v[72:87]
    s_waitcnt lgkmcnt(0)
    s_barrier
    ds_read_b128 v[24:27], v14 offset:0
    ds_read_b64_tr_b16 v[40:41], v18 offset:16384
    ds_read_b64_tr_b16 v[42:43], v18 offset:16640
    ds_read_b64_tr_b16 v[44:45], v18 offset:20480
    ds_read_b64_tr_b16 v[46:47], v18 offset:20736
    v_mfma_f32_32x32x16_bf16 v[56:71], v[32:35], v[48:51], v[56:71]
    v_mfma_f32_32x32x16_bf16 v[72:87], v[32:35], v[52:55], v[72:87]
    s_waitcnt lgkmcnt(0)
    ds_read_b128 v[32:35], v15 offset:0
    ds_read_b64_tr_b16 v[48:49], v18 offset:17408
    ds_read_b64_tr_b16 v[50:51], v18 offset:17664
    ds_read_b64_tr_b16 v[52:53], v18 offset:21504
    ds_read_b64_tr_b16 v[54:55], v18 offset:21760
    v_mfma_f32_32x32x16_bf16 v[56:71], v[24:27], v[40:43], v[56:71]
    v_mfma_f32_32x32x16_bf16 v[72:87], v[24:27], v[44:47], v[72:87]
    s_waitcnt lgkmcnt(0)
    ds_read_b128 v[24:27], v16 offset:0
    ds_read_b64_tr_b16 v[40:41], v18 offset:18432
    ds_read_b64_tr_b16 v[42:43], v18 offset:18688
    ds_read_b64_tr_b16 v[44:45], v18 offset:22528
    ds_read_b64_tr_b16 v[46:47], v18 offset:22784
    v_mfma_f32_32x32x16_bf16 v[56:71], v[32:35], v[48:51], v[56:71]
    v_mfma_f32_32x32x16_bf16 v[72:87], v[32:35], v[52:55], v[72:87]
    s_waitcnt lgkmcnt(0)
    ds_read_b128 v[32:35], v17 offset:0
    ds_read_b64_tr_b16 v[48:49], v18 offset:19456
    ds_read_b64_tr_b16 v[50:51], v18 offset:19712
    ds_read_b64_tr_b16 v[52:53], v18 offset:23552
    ds_read_b64_tr_b16 v[54:55], v18 offset:23808
    v_mfma_f32_32x32x16_bf16 v[56:71], v[24:27], v[40:43], v[56:71]
    v_mfma_f32_32x32x16_bf16 v[72:87], v[24:27], v[44:47], v[72:87]
    s_waitcnt lgkmcnt(0)
    s_barrier
    ds_read_b128 v[24:27], v14 offset:16384
    ds_read_b64_tr_b16 v[40:41], v18 offset:32768
    ds_read_b64_tr_b16 v[42:43], v18 offset:33024
    ds_read_b64_tr_b16 v[44:45], v18 offset:36864
    ds_read_b64_tr_b16 v[46:47], v18 offset:37120
    v_mfma_f32_32x32x16_bf16 v[56:71], v[32:35], v[48:51], v[56:71]
    v_mfma_f32_32x32x16_bf16 v[72:87], v[32:35], v[52:55], v[72:87]
    s_waitcnt lgkmcnt(0)
    ds_read_b128 v[32:35], v15 offset:16384
    ds_read_b64_tr_b16 v[48:49], v18 offset:33792
    ds_read_b64_tr_b16 v[50:51], v18 offset:34048
    ds_read_b64_tr_b16 v[52:53], v18 offset:37888
    ds_read_b64_tr_b16 v[54:55], v18 offset:38144
    v_mfma_f32_32x32x16_bf16 v[56:71], v[24:27], v[40:43], v[56:71]
    v_mfma_f32_32x32x16_bf16 v[72:87], v[24:27], v[44:47], v[72:87]
    s_waitcnt lgkmcnt(0)
    ds_read_b128 v[24:27], v16 offset:16384
    ds_read_b64_tr_b16 v[40:41], v18 offset:34816
    ds_read_b64_tr_b16 v[42:43], v18 offset:35072
    ds_read_b64_tr_b16 v[44:45], v18 offset:38912
    ds_read_b64_tr_b16 v[46:47], v18 offset:39168
    v_mfma_f32_32x32x16_bf16 v[56:71], v[32:35], v[48:51], v[56:71]
    v_mfma_f32_32x32x16_bf16 v[72:87], v[32:35], v[52:55], v[72:87]
    s_waitcnt lgkmcnt(0)
    ds_read_b128 v[32:35], v17 offset:16384
    ds_read_b64_tr_b16 v[48:49], v18 offset:35840
    ds_read_b64_tr_b16 v[50:51], v18 offset:36096
    ds_read_b64_tr_b16 v[52:53], v18 offset:39936
    ds_read_b64_tr_b16 v[54:55], v18 offset:40192
    v_mfma_f32_32x32x16_bf16 v[56:71], v[24:27], v[40:43], v[56:71]
    v_mfma_f32_32x32x16_bf16 v[72:87], v[24:27], v[44:47], v[72:87]
    s_waitcnt lgkmcnt(0)
    s_barrier
    ds_read_b128 v[24:27], v14 offset:32768
    ds_read_b64_tr_b16 v[40:41], v18 offset:0
    ds_read_b64_tr_b16 v[42:43], v18 offset:256
    ds_read_b64_tr_b16 v[44:45], v18 offset:4096
    ds_read_b64_tr_b16 v[46:47], v18 offset:4352
    v_mfma_f32_32x32x16_bf16 v[56:71], v[32:35], v[48:51], v[56:71]
    v_mfma_f32_32x32x16_bf16 v[72:87], v[32:35], v[52:55], v[72:87]
    s_waitcnt lgkmcnt(0)
    ds_read_b128 v[32:35], v15 offset:32768
    ds_read_b64_tr_b16 v[48:49], v18 offset:1024
    ds_read_b64_tr_b16 v[50:51], v18 offset:1280
    ds_read_b64_tr_b16 v[52:53], v18 offset:5120
    ds_read_b64_tr_b16 v[54:55], v18 offset:5376
    v_mfma_f32_32x32x16_bf16 v[56:71], v[24:27], v[40:43], v[56:71]
    v_mfma_f32_32x32x16_bf16 v[72:87], v[24:27], v[44:47], v[72:87]
    s_waitcnt lgkmcnt(0)
    ds_read_b128 v[24:27], v16 offset:32768
    ds_read_b64_tr_b16 v[40:41], v18 offset:2048
    ds_read_b64_tr_b16 v[42:43], v18 offset:2304
    ds_read_b64_tr_b16 v[44:45], v18 offset:6144
    ds_read_b64_tr_b16 v[46:47], v18 offset:6400
    v_mfma_f32_32x32x16_bf16 v[56:71], v[32:35], v[48:51], v[56:71]
    v_mfma_f32_32x32x16_bf16 v[72:87], v[32:35], v[52:55], v[72:87]
    s_waitcnt lgkmcnt(0)
    ds_read_b128 v[32:35], v17 offset:32768
    ds_read_b64_tr_b16 v[48:49], v18 offset:3072
    ds_read_b64_tr_b16 v[50:51], v18 offset:3328
    ds_read_b64_tr_b16 v[52:53], v18 offset:7168
    ds_read_b64_tr_b16 v[54:55], v18 offset:7424
    v_mfma_f32_32x32x16_bf16 v[56:71], v[24:27], v[40:43], v[56:71]
    v_mfma_f32_32x32x16_bf16 v[72:87], v[24:27], v[44:47], v[72:87]
    s_waitcnt lgkmcnt(0)
    v_mfma_f32_32x32x16_bf16 v[56:71], v[32:35], v[48:51], v[56:71]
    v_mfma_f32_32x32x16_bf16 v[72:87], v[32:35], v[52:55], v[72:87]
    global_load_dwordx2 v[164:165], v152, s[22:23] sc1
    s_barrier
    v_add_u32 v10, s43, v10
    v_add_u32 v11, s43, v11
    v_add_u32 v12, s43, v12
    v_add_u32 v13, s43, v13
    v_add_u32 v14, s43, v14
    v_add_u32 v15, s43, v15
    v_add_u32 v16, s43, v16
    v_add_u32 v17, s43, v17
    ds_read_b128 v[24:27], v10 offset:0
    ds_read_b128 v[28:31], v10 offset:4096
    ds_read_b64_tr_b16 v[40:41], v21 offset:16384
    ds_read_b64_tr_b16 v[42:43], v21 offset:16896
    ds_read_b64_tr_b16 v[44:45], v22 offset:16384
    ds_read_b64_tr_b16 v[46:47], v22 offset:16896
    v_mov_b32 v144, 0x3f803f80
    v_cndmask_b32 v144, 0, v144, s[54:55]
    v_cvt_pk_bf16_f32 v56, v56, v57
    v_cvt_pk_bf16_f32 v57, v58, v59
    v_cvt_pk_bf16_f32 v58, v60, v61
    v_cvt_pk_bf16_f32 v59, v62, v63
    v_cvt_pk_bf16_f32 v60, v64, v65
    v_cvt_pk_bf16_f32 v61, v66, v67
    v_cvt_pk_bf16_f32 v62, v68, v69
    v_cvt_pk_bf16_f32 v63, v70, v71
    v_cndmask_b32 v56, v56, v144, s[46:47]
    v_cndmask_b32 v57, v57, v144, s[46:47]
    v_cndmask_b32 v58, v58, v144, s[46:47]
    v_cndmask_b32 v59, v59, v144, s[46:47]
    v_cndmask_b32 v60, v60, v144, s[46:47]
    v_cndmask_b32 v61, v61, v144, s[46:47]
    v_cndmask_b32 v62, v62, v144, s[46:47]
    v_cndmask_b32 v63, v63, v144, s[46:47]
    s_add_u32 s38, s38, 2048
    v_mov_b32 v144, 0x3f803f80
    v_cndmask_b32 v144, 0, v144, s[54:55]
    v_cvt_pk_bf16_f32 v72, v72, v73
    v_cvt_pk_bf16_f32 v73, v74, v75
    v_cvt_pk_bf16_f32 v74, v76, v77
    v_cvt_pk_bf16_f32 v75, v78, v79
    v_cvt_pk_bf16_f32 v76, v80, v81
    v_cvt_pk_bf16_f32 v77, v82, v83
    v_cvt_pk_bf16_f32 v78, v84, v85
    v_cvt_pk_bf16_f32 v79, v86, v87
    v_cndmask_b32 v72, v72, v144, s[46:47]
    v_cndmask_b32 v73, v73, v144, s[46:47]
    v_cndmask_b32 v74, v74, v144, s[46:47]
    v_cndmask_b32 v75, v75, v144, s[46:47]
    v_cndmask_b32 v76, v76, v144, s[46:47]
    v_cndmask_b32 v77, v77, v144, s[46:47]
    v_cndmask_b32 v78, v78, v144, s[46:47]
    v_cndmask_b32 v79, v79, v144, s[46:47]
    s_add_u32 s39, s39, 2048
    s_branch P2_START
P1_Y:
    s_cmp_ge_u32 s60, 32
    s_cbranch_scc1 P1_YV
P1_YN:
    s_barrier
    ds_read_b128 v[24:27], v10 offset:0
    ds_read_b64_tr_b16 v[40:41], v18 offset:0
    ds_read_b64_tr_b16 v[42:43], v18 offset:256
    s_waitcnt lgkmcnt(0)
    ds_read_b128 v[32:35], v11 offset:0
    ds_read_b64_tr_b16 v[48:49], v18 offset:1024
    ds_read_b64_tr_b16 v[50:51], v18 offset:1280
    v_mfma_f32_32x32x16_bf16 v[56:71], v[40:43], v[24:27], 0
    s_waitcnt lgkmcnt(0)
    ds_read_b128 v[24:27], v12 offset:0
    ds_read_b64_tr_b16 v[40:41], v18 offset:2048
    ds_read_b64_tr_b16 v[42:43], v18 offset:2304
    v_mfma_f32_32x32x16_bf16 v[56:71], v[48:51], v[32:35], v[56:71]
    s_waitcnt lgkmcnt(0)
    ds_read_b128 v[32:35], v13 offset:0
    ds_read_b64_tr_b16 v[48:49], v18 offset:3072
    ds_read_b64_tr_b16 v[50:51], v18 offset:3328
    v_mfma_f32_32x32x16_bf16 v[56:71], v[40:43], v[24:27], v[56:71]
    s_waitcnt lgkmcnt(0)
    s_barrier
    ds_read_b128 v[24:27], v10 offset:16384
    ds_read_b64_tr_b16 v[40:41], v18 offset:16384
    ds_read_b64_tr_b16 v[42:43], v18 offset:16640
    v_mfma_f32_32x32x16_bf16 v[56:71], v[48:51], v[32:35], v[56:71]
    s_waitcnt lgkmcnt(0)
    ds_read_b128 v[32:35], v11 offset:16384
    ds_read_b64_tr_b16 v[48:49], v18 offset:17408
    ds_read_b64_tr_b16 v[50:51], v18 offset:17664
    v_mfma_f32_32x32x16_bf16 v[56:71], v[40:43], v[24:27], v[56:71]
    s_waitcnt lgkmcnt(0)
    ds_read_b128 v[24:27], v12 offset:16384
    ds_read_b64_tr_b16 v[40:41], v18 offset:18432
    ds_read_b64_tr_b16 v[42:43], v18 offset:18688
    v_mfma_f32_32x32x16_bf16 v[56:71], v[48:51], v[32:35], v[56:71]
    s_waitcnt lgkmcnt(0)
    ds_read_b128 v[32:35], v13 offset:16384
    ds_read_b64_tr_b16 v[48:49], v18 offset:19456
    ds_read_b64_tr_b16 v[50:51], v18 offset:19712
    v_mfma_f32_32x32x16_bf16 v[56:71], v[40:43], v[24:27], v[56:71]
    s_waitcnt lgkmcnt(0)
    s_barrier
    ds_read_b128 v[24:27], v10 offset:32768
    ds_read_b64_tr_b16 v[40:41], v18 offset:32768
    ds_read_b64_tr_b16 v[42:43], v18 offset:33024
    v_mfma_f32_32x32x16_bf16 v[56:71], v[48:51], v[32:35], v[56:71]
    s_waitcnt lgkmcnt(0)
    ds_read_b128 v[32:35], v11 offset:32768
    ds_read_b64_tr_b16 v[48:49], v18 offset:33792
    ds_read_b64_tr_b16 v[50:51], v18 offset:34048
    v_mfma_f32_32x32x16_bf16 v[56:71], v[40:43], v[24:27], v[56:71]
    s_waitcnt lgkmcnt(0)
    ds_read_b128 v[24:27], v12 offset:32768
    ds_read_b64_tr_b16 v[40:41], v18 offset:34816
    ds_read_b64_tr_b16 v[42:43], v18 offset:35072
    v_mfma_f32_32x32x16_bf16 v[56:71], v[48:51], v[32:35], v[56:71]
    s_waitcnt lgkmcnt(0)
    ds_read_b128 v[32:35], v13 offset:32768
    ds_read_b64_tr_b16 v[48:49], v18 offset:35840
    ds_read_b64_tr_b16 v[50:51], v18 offset:36096
    v_mfma_f32_32x32x16_bf16 v[56:71], v[40:43], v[24:27], v[56:71]
    s_waitcnt lgkmcnt(0)
    s_barrier
    ds_read_b128 v[24:27], v10 offset:49152
    ds_read_b64_tr_b16 v[40:41], v18 offset:0
    ds_read_b64_tr_b16 v[42:43], v18 offset:256
    v_mfma_f32_32x32x16_bf16 v[56:71], v[48:51], v[32:35], v[56:71]
    s_waitcnt lgkmcnt(0)
    ds_read_b128 v[32:35], v11 offset:49152
    ds_read_b64_tr_b16 v[48:49], v18 offset:1024
    ds_read_b64_tr_b16 v[50:51], v18 offset:1280
    v_mfma_f32_32x32x16_bf16 v[56:71], v[40:43], v[24:27], v[56:71]
    s_waitcnt lgkmcnt(0)
    ds_read_b128 v[24:27], v12 offset:49152
    ds_read_b64_tr_b16 v[40:41], v18 offset:2048
    ds_read_b64_tr_b16 v[42:43], v18 offset:2304
    v_mfma_f32_32x32x16_bf16 v[56:71], v[48:51], v[32:35], v[56:71]
    s_waitcnt lgkmcnt(0)
    ds_read_b128 v[32:35], v13 offset:49152
    ds_read_b64_tr_b16 v[48:49], v18 offset:3072
    ds_read_b64_tr_b16 v[50:51], v18 offset:3328
    v_mfma_f32_32x32x16_bf16 v[56:71], v[40:43], v[24:27], v[56:71]
    s_waitcnt lgkmcnt(0)
    s_barrier
    ds_read_b128 v[24:27], v14 offset:0
    ds_read_b64_tr_b16 v[40:41], v18 offset:16384
    ds_read_b64_tr_b16 v[42:43], v18 offset:16640
    v_mfma_f32_32x32x16_bf16 v[56:71], v[48:51], v[32:35], v[56:71]
    s_waitcnt lgkmcnt(0)
    ds_read_b128 v[32:35], v15 offset:0
    ds_read_b64_tr_b16 v[48:49], v18 offset:17408
    ds_read_b64_tr_b16 v[50:51], v18 offset:17664
    v_mfma_f32_32x32x16_bf16 v[56:71], v[40:43], v[24:27], v[56:71]
    s_waitcnt lgkmcnt(0)
    ds_read_b128 v[24:27], v16 offset:0
    ds_read_b64_tr_b16 v[40:41], v18 offset:18432
    ds_read_b64_tr_b16 v[42:43], v18 offset:18688
    v_mfma_f32_32x32x16_bf16 v[56:71], v[48:51], v[32:35], v[56:71]
    s_waitcnt lgkmcnt(0)
    ds_read_b128 v[32:35], v17 offset:0
    ds_read_b64_tr_b16 v[48:49], v18 offset:19456
    ds_read_b64_tr_b16 v[50:51], v18 offset:19712
    v_mfma_f32_32x32x16_bf16 v[56:71], v[40:43], v[24:27], v[56:71]
    s_waitcnt lgkmcnt(0)
    s_barrier
    ds_read_b128 v[24:27], v14 offset:16384
    ds_read_b64_tr_b16 v[40:41], v18 offset:32768
    ds_read_b64_tr_b16 v[42:43], v18 offset:33024
    v_mfma_f32_32x32x16_bf16 v[56:71], v[48:51], v[32:35], v[56:71]
    s_waitcnt lgkmcnt(0)
    ds_read_b128 v[32:35], v15 offset:16384
    ds_read_b64_tr_b16 v[48:49], v18 offset:33792
    ds_read_b64_tr_b16 v[50:51], v18 offset:34048
    v_mfma_f32_32x32x16_bf16 v[56:71], v[40:43], v[24:27], v[56:71]
    s_waitcnt lgkmcnt(0)
    ds_read_b128 v[24:27], v16 offset:16384
    ds_read_b64_tr_b16 v[40:41], v18 offset:34816
    ds_read_b64_tr_b16 v[42:43], v18 offset:35072
    v_mfma_f32_32x32x16_bf16 v[56:71], v[48:51], v[32:35], v[56:71]
    s_waitcnt lgkmcnt(0)
    ds_read_b128 v[32:35], v17 offset:16384
    ds_read_b64_tr_b16 v[48:49], v18 offset:35840
    ds_read_b64_tr_b16 v[50:51], v18 offset:36096
    v_mfma_f32_32x32x16_bf16 v[56:71], v[40:43], v[24:27], v[56:71]
    s_waitcnt lgkmcnt(0)
    s_barrier
    ds_read_b128 v[24:27], v14 offset:32768
    ds_read_b64_tr_b16 v[40:41], v18 offset:0
    ds_read_b64_tr_b16 v[42:43], v18 offset:256
    v_mfma_f32_32x32x16_bf16 v[56:71], v[48:51], v[32:35], v[56:71]
    s_waitcnt lgkmcnt(0)
    ds_read_b128 v[32:35], v15 offset:32768
    ds_read_b64_tr_b16 v[48:49], v18 offset:1024
    ds_read_b64_tr_b16 v[50:51], v18 offset:1280
    v_mfma_f32_32x32x16_bf16 v[56:71], v[40:43], v[24:27], v[56:71]
    s_waitcnt lgkmcnt(0)
    ds_read_b128 v[24:27], v16 offset:32768
    ds_read_b64_tr_b16 v[40:41], v18 offset:2048
    ds_read_b64_tr_b16 v[42:43], v18 offset:2304
    v_mfma_f32_32x32x16_bf16 v[56:71], v[48:51], v[32:35], v[56:71]
    s_waitcnt lgkmcnt(0)
    ds_read_b128 v[32:35], v17 offset:32768
    ds_read_b64_tr_b16 v[48:49], v18 offset:3072
    ds_read_b64_tr_b16 v[50:51], v18 offset:3328
    v_mfma_f32_32x32x16_bf16 v[56:71], v[40:43], v[24:27], v[56:71]
    s_waitcnt lgkmcnt(0)
    v_mfma_f32_32x32x16_bf16 v[56:71], v[48:51], v[32:35], v[56:71]
    global_load_dwordx2 v[164:165], v152, s[22:23] sc1
    s_barrier
    v_add_u32 v10, s43, v10
    v_add_u32 v11, s43, v11
    v_add_u32 v12, s43, v12
    v_add_u32 v13, s43, v13
    v_add_u32 v14, s43, v14
    v_add_u32 v15, s43, v15
    v_add_u32 v16, s43, v16
    v_add_u32 v17, s43, v17
    ds_read_b128 v[24:27], v10 offset:0
    ds_read_b128 v[28:31], v10 offset:4096
    ds_read_b64_tr_b16 v[40:41], v21 offset:16384
    ds_read_b64_tr_b16 v[42:43], v21 offset:16896
    ds_read_b64_tr_b16 v[44:45], v22 offset:16384
    ds_read_b64_tr_b16 v[46:47], v22 offset:16896
    v_mul_f32 v56, s32, v56
    v_mul_f32 v57, s32, v57
    v_mul_f32 v58, s32, v58
    v_mul_f32 v59, s32, v59
    v_mul_f32 v60, s32, v60
    v_mul_f32 v61, s32, v61
    v_mul_f32 v62, s32, v62
    v_mul_f32 v63, s32, v63
    v_mul_f32 v64, s32, v64
    v_mul_f32 v65, s32, v65
    v_mul_f32 v66, s32, v66
    v_mul_f32 v67, s32, v67
    v_mul_f32 v68, s32, v68
    v_mul_f32 v69, s32, v69
    v_mul_f32 v70, s32, v70
    v_mul_f32 v71, s32, v71
    v_mov_b32 v144, s36
    v_cvt_pk_bf16_f32 v56, v56, v57
    v_cvt_pk_bf16_f32 v57, v58, v59
    v_cvt_pk_bf16_f32 v58, v60, v61
    v_cvt_pk_bf16_f32 v59, v62, v63
    v_cvt_pk_bf16_f32 v60, v64, v65
    v_cvt_pk_bf16_f32 v61, v66, v67
    v_cvt_pk_bf16_f32 v62, v68, v69
    v_cvt_pk_bf16_f32 v63, v70, v71
    v_cndmask_b32 v62, v62, v144, s[52:53]
    v_cndmask_b32 v63, v63, 0, s[52:53]
    s_branch P2_START
P1_YV:
    s_barrier
    ds_read_b128 v[24:27], v10 offset:0
    ds_read_b64_tr_b16 v[40:41], v18 offset:0
    ds_read_b64_tr_b16 v[42:43], v18 offset:256
    s_waitcnt lgkmcnt(0)
    ds_read_b128 v[32:35], v11 offset:0
    ds_read_b64_tr_b16 v[48:49], v18 offset:1024
    ds_read_b64_tr_b16 v[50:51], v18 offset:1280
    v_mfma_f32_32x32x16_bf16 v[56:71], v[24:27], v[40:43], 0
    s_waitcnt lgkmcnt(0)
    ds_read_b128 v[24:27], v12 offset:0
    ds_read_b64_tr_b16 v[40:41], v18 offset:2048
    ds_read_b64_tr_b16 v[42:43], v18 offset:2304
    v_mfma_f32_32x32x16_bf16 v[56:71], v[32:35], v[48:51], v[56:71]
    s_waitcnt lgkmcnt(0)
    ds_read_b128 v[32:35], v13 offset:0
    ds_read_b64_tr_b16 v[48:49], v18 offset:3072
    ds_read_b64_tr_b16 v[50:51], v18 offset:3328
    v_mfma_f32_32x32x16_bf16 v[56:71], v[24:27], v[40:43], v[56:71]
    s_waitcnt lgkmcnt(0)
    s_barrier
    ds_read_b128 v[24:27], v10 offset:16384
    ds_read_b64_tr_b16 v[40:41], v18 offset:16384
    ds_read_b64_tr_b16 v[42:43], v18 offset:16640
    v_mfma_f32_32x32x16_bf16 v[56:71], v[32:35], v[48:51], v[56:71]
    s_waitcnt lgkmcnt(0)
    ds_read_b128 v[32:35], v11 offset:16384
    ds_read_b64_tr_b16 v[48:49], v18 offset:17408
    ds_read_b64_tr_b16 v[50:51], v18 offset:17664
    v_mfma_f32_32x32x16_bf16 v[56:71], v[24:27], v[40:43], v[56:71]
    s_waitcnt lgkmcnt(0)
    ds_read_b128 v[24:27], v12 offset:16384
    ds_read_b64_tr_b16 v[40:41], v18 offset:18432
    ds_read_b64_tr_b16 v[42:43], v18 offset:18688
    v_mfma_f32_32x32x16_bf16 v[56:71], v[32:35], v[48:51], v[56:71]
    s_waitcnt lgkmcnt(0)
    ds_read_b128 v[32:35], v13 offset:16384
    ds_read_b64_tr_b16 v[48:49], v18 offset:19456
    ds_read_b64_tr_b16 v[50:51], v18 offset:19712
    v_mfma_f32_32x32x16_bf16 v[56:71], v[24:27], v[40:43], v[56:71]
    s_waitcnt lgkmcnt(0)
    s_barrier
    ds_read_b128 v[24:27], v10 offset:32768
    ds_read_b64_tr_b16 v[40:41], v18 offset:32768
    ds_read_b64_tr_b16 v[42:43], v18 offset:33024
    v_mfma_f32_32x32x16_bf16 v[56:71], v[32:35], v[48:51], v[56:71]
    s_waitcnt lgkmcnt(0)
    ds_read_b128 v[32:35], v11 offset:32768
    ds_read_b64_tr_b16 v[48:49], v18 offset:33792
    ds_read_b64_tr_b16 v[50:51], v18 offset:34048
    v_mfma_f32_32x32x16_bf16 v[56:71], v[24:27], v[40:43], v[56:71]
    s_waitcnt lgkmcnt(0)
    ds_read_b128 v[24:27], v12 offset:32768
    ds_read_b64_tr_b16 v[40:41], v18 offset:34816
    ds_read_b64_tr_b16 v[42:43], v18 offset:35072
    v_mfma_f32_32x32x16_bf16 v[56:71], v[32:35], v[48:51], v[56:71]
    s_waitcnt lgkmcnt(0)
    ds_read_b128 v[32:35], v13 offset:32768
    ds_read_b64_tr_b16 v[48:49], v18 offset:35840
    ds_read_b64_tr_b16 v[50:51], v18 offset:36096
    v_mfma_f32_32x32x16_bf16 v[56:71], v[24:27], v[40:43], v[56:71]
    s_waitcnt lgkmcnt(0)
    s_barrier
    ds_read_b128 v[24:27], v10 offset:49152
    ds_read_b64_tr_b16 v[40:41], v18 offset:0
    ds_read_b64_tr_b16 v[42:43], v18 offset:256
    v_mfma_f32_32x32x16_bf16 v[56:71], v[32:35], v[48:51], v[56:71]
    s_waitcnt lgkmcnt(0)
    ds_read_b128 v[32:35], v11 offset:49152
    ds_read_b64_tr_b16 v[48:49], v18 offset:1024
    ds_read_b64_tr_b16 v[50:51], v18 offset:1280
    v_mfma_f32_32x32x16_bf16 v[56:71], v[24:27], v[40:43], v[56:71]
    s_waitcnt lgkmcnt(0)
    ds_read_b128 v[24:27], v12 offset:49152
    ds_read_b64_tr_b16 v[40:41], v18 offset:2048
    ds_read_b64_tr_b16 v[42:43], v18 offset:2304
    v_mfma_f32_32x32x16_bf16 v[56:71], v[32:35], v[48:51], v[56:71]
    s_waitcnt lgkmcnt(0)
    ds_read_b128 v[32:35], v13 offset:49152
    ds_read_b64_tr_b16 v[48:49], v18 offset:3072
    ds_read_b64_tr_b16 v[50:51], v18 offset:3328
    v_mfma_f32_32x32x16_bf16 v[56:71], v[24:27], v[40:43], v[56:71]
    s_waitcnt lgkmcnt(0)
    s_barrier
    ds_read_b128 v[24:27], v14 offset:0
    ds_read_b64_tr_b16 v[40:41], v18 offset:16384
    ds_read_b64_tr_b16 v[42:43], v18 offset:16640
    v_mfma_f32_32x32x16_bf16 v[56:71], v[32:35], v[48:51], v[56:71]
    s_waitcnt lgkmcnt(0)
    ds_read_b128 v[32:35], v15 offset:0
    ds_read_b64_tr_b16 v[48:49], v18 offset:17408
    ds_read_b64_tr_b16 v[50:51], v18 offset:17664
    v_mfma_f32_32x32x16_bf16 v[56:71], v[24:27], v[40:43], v[56:71]
    s_waitcnt lgkmcnt(0)
    ds_read_b128 v[24:27], v16 offset:0
    ds_read_b64_tr_b16 v[40:41], v18 offset:18432
    ds_read_b64_tr_b16 v[42:43], v18 offset:18688
    v_mfma_f32_32x32x16_bf16 v[56:71], v[32:35], v[48:51], v[56:71]
    s_waitcnt lgkmcnt(0)
    ds_read_b128 v[32:35], v17 offset:0
    ds_read_b64_tr_b16 v[48:49], v18 offset:19456
    ds_read_b64_tr_b16 v[50:51], v18 offset:19712
    v_mfma_f32_32x32x16_bf16 v[56:71], v[24:27], v[40:43], v[56:71]
    s_waitcnt lgkmcnt(0)
    s_barrier
    ds_read_b128 v[24:27], v14 offset:16384
    ds_read_b64_tr_b16 v[40:41], v18 offset:32768
    ds_read_b64_tr_b16 v[42:43], v18 offset:33024
    v_mfma_f32_32x32x16_bf16 v[56:71], v[32:35], v[48:51], v[56:71]
    s_waitcnt lgkmcnt(0)
    ds_read_b128 v[32:35], v15 offset:16384
    ds_read_b64_tr_b16 v[48:49], v18 offset:33792
    ds_read_b64_tr_b16 v[50:51], v18 offset:34048
    v_mfma_f32_32x32x16_bf16 v[56:71], v[24:27], v[40:43], v[56:71]
    s_waitcnt lgkmcnt(0)
    ds_read_b128 v[24:27], v16 offset:16384
    ds_read_b64_tr_b16 v[40:41], v18 offset:34816
    ds_read_b64_tr_b16 v[42:43], v18 offset:35072
    v_mfma_f32_32x32x16_bf16 v[56:71], v[32:35], v[48:51], v[56:71]
    s_waitcnt lgkmcnt(0)
    ds_read_b128 v[32:35], v17 offset:16384
    ds_read_b64_tr_b16 v[48:49], v18 offset:35840
    ds_read_b64_tr_b16 v[50:51], v18 offset:36096
    v_mfma_f32_32x32x16_bf16 v[56:71], v[24:27], v[40:43], v[56:71]
    s_waitcnt lgkmcnt(0)
    s_barrier
    ds_read_b128 v[24:27], v14 offset:32768
    ds_read_b64_tr_b16 v[40:41], v18 offset:0
    ds_read_b64_tr_b16 v[42:43], v18 offset:256
    v_mfma_f32_32x32x16_bf16 v[56:71], v[32:35], v[48:51], v[56:71]
    s_waitcnt lgkmcnt(0)
    ds_read_b128 v[32:35], v15 offset:32768
    ds_read_b64_tr_b16 v[48:49], v18 offset:1024
    ds_read_b64_tr_b16 v[50:51], v18 offset:1280
    v_mfma_f32_32x32x16_bf16 v[56:71], v[24:27], v[40:43], v[56:71]
    s_waitcnt lgkmcnt(0)
    ds_read_b128 v[24:27], v16 offset:32768
    ds_read_b64_tr_b16 v[40:41], v18 offset:2048
    ds_read_b64_tr_b16 v[42:43], v18 offset:2304
    v_mfma_f32_32x32x16_bf16 v[56:71], v[32:35], v[48:51], v[56:71]
    s_waitcnt lgkmcnt(0)
    ds_read_b128 v[32:35], v17 offset:32768
    ds_read_b64_tr_b16 v[48:49], v18 offset:3072
    ds_read_b64_tr_b16 v[50:51], v18 offset:3328
    v_mfma_f32_32x32x16_bf16 v[56:71], v[24:27], v[40:43], v[56:71]
    s_waitcnt lgkmcnt(0)
    v_mfma_f32_32x32x16_bf16 v[56:71], v[32:35], v[48:51], v[56:71]
    global_load_dwordx2 v[164:165], v152, s[22:23] sc1
    s_barrier
    v_add_u32 v10, s43, v10
    v_add_u32 v11, s43, v11
    v_add_u32 v12, s43, v12
    v_add_u32 v13, s43, v13
    v_add_u32 v14, s43, v14
    v_add_u32 v15, s43, v15
    v_add_u32 v16, s43, v16
    v_add_u32 v17, s43, v17
    ds_read_b128 v[24:27], v10 offset:0
    ds_read_b128 v[28:31], v10 offset:4096
    ds_read_b64_tr_b16 v[40:41], v21 offset:16384
    ds_read_b64_tr_b16 v[42:43], v21 offset:16896
    ds_read_b64_tr_b16 v[44:45], v22 offset:16384
    ds_read_b64_tr_b16 v[46:47], v22 offset:16896
    v_mov_b32 v144, 0x3f803f80
    v_cndmask_b32 v144, 0, v144, s[54:55]
    v_cvt_pk_bf16_f32 v56, v56, v57
    v_cvt_pk_bf16_f32 v57, v58, v59
    v_cvt_pk_bf16_f32 v58, v60, v61
    v_cvt_pk_bf16_f32 v59, v62, v63
    v_cvt_pk_bf16_f32 v60, v64, v65
    v_cvt_pk_bf16_f32 v61, v66, v67
    v_cvt_pk_bf16_f32 v62, v68, v69
    v_cvt_pk_bf16_f32 v63, v70, v71
    v_cndmask_b32 v56, v56, v144, s[46:47]
    v_cndmask_b32 v57, v57, v144, s[46:47]
    v_cndmask_b32 v58, v58, v144, s[46:47]
    v_cndmask_b32 v59, v59, v144, s[46:47]
    v_cndmask_b32 v60, v60, v144, s[46:47]
    v_cndmask_b32 v61, v61, v144, s[46:47]
    v_cndmask_b32 v62, v62, v144, s[46:47]
    v_cndmask_b32 v63, v63, v144, s[46:47]
    s_add_u32 s38, s38, 2048
P2_START:
    s_cmp_eq_u32 s58, 1
    s_cbranch_scc1 P2_IDLE
    s_waitcnt lgkmcnt(0)
    v_mfma_f32_32x32x16_bf16 v[80:95], v[40:43], v[24:27], 0
    ds_read_b128 v[32:35], v11 offset:0
    ds_read_b128 v[36:39], v11 offset:4096
    ds_read_b64_tr_b16 v[48:49], v21 offset:18432
    v_mfma_f32_32x32x16_bf16 v[96:111], v[40:43], v[28:31], 0
    ds_read_b64_tr_b16 v[50:51], v21 offset:18944
    ds_read_b64_tr_b16 v[52:53], v22 offset:18432
    ds_read_b64_tr_b16 v[54:55], v22 offset:18944
    v_mfma_f32_32x32x16_bf16 v[112:127], v[44:47], v[24:27], 0
    v_mfma_f32_32x32x16_bf16 v[128:143], v[44:47], v[28:31], 0
    buffer_store_dwordx4 v[56:59], v23, s[28:31], s38 offen offset:0 sc1
    s_waitcnt lgkmcnt(0)
    s_barrier
    v_mfma_f32_32x32x16_bf16 v[80:95], v[48:51], v[32:35], v[80:95]
    ds_read_b128 v[24:27], v12 offset:0
    ds_read_b128 v[28:31], v12 offset:4096
    ds_read_b64_tr_b16 v[40:41], v21 offset:32768
    v_mfma_f32_32x32x16_bf16 v[96:111], v[48:51], v[36:39], v[96:111]
    ds_read_b64_tr_b16 v[42:43], v21 offset:33280
    ds_read_b64_tr_b16 v[44:45], v22 offset:32768
    ds_read_b64_tr_b16 v[46:47], v22 offset:33280
    v_mfma_f32_32x32x16_bf16 v[112:127], v[52:55], v[32:35], v[112:127]
    v_mfma_f32_32x32x16_bf16 v[128:143], v[52:55], v[36:39], v[128:143]
    s_waitcnt lgkmcnt(0)
    v_mfma_f32_32x32x16_bf16 v[80:95], v[40:43], v[24:27], v[80:95]
    ds_read_b128 v[32:35], v13 offset:0
    ds_read_b128 v[36:39], v13 offset:4096
    ds_read_b64_tr_b16 v[48:49], v21 offset:34816
    v_mfma_f32_32x32x16_bf16 v[96:111], v[40:43], v[28:31], v[96:111]
    ds_read_b64_tr_b16 v[50:51], v21 offset:35328
    ds_read_b64_tr_b16 v[52:53], v22 offset:34816
    ds_read_b64_tr_b16 v[54:55], v22 offset:35328
    v_mfma_f32_32x32x16_bf16 v[112:127], v[44:47], v[24:27], v[112:127]
    v_mfma_f32_32x32x16_bf16 v[128:143], v[44:47], v[28:31], v[128:143]
    buffer_store_dwordx4 v[60:63], v23, s[28:31], s38 offen offset:1024 sc1
    s_waitcnt lgkmcnt(0)
    s_barrier
    v_mfma_f32_32x32x16_bf16 v[80:95], v[48:51], v[32:35], v[80:95]
    ds_read_b128 v[24:27], v10 offset:16384
    ds_read_b128 v[28:31], v10 offset:20480
    ds_read_b64_tr_b16 v[40:41], v21 offset:0
    v_mfma_f32_32x32x16_bf16 v[96:111], v[48:51], v[36:39], v[96:111]
    ds_read_b64_tr_b16 v[42:43], v21 offset:512
    ds_read_b64_tr_b16 v[44:45], v22 offset:0
    ds_read_b64_tr_b16 v[46:47], v22 offset:512
    v_mfma_f32_32x32x16_bf16 v[112:127], v[52:55], v[32:35], v[112:127]
    v_mfma_f32_32x32x16_bf16 v[128:143], v[52:55], v[36:39], v[128:143]
    s_waitcnt lgkmcnt(0)
    v_mfma_f32_32x32x16_bf16 v[80:95], v[40:43], v[24:27], v[80:95]
    ds_read_b128 v[32:35], v11 offset:16384
    ds_read_b128 v[36:39], v11 offset:20480
    ds_read_b64_tr_b16 v[48:49], v21 offset:2048
    v_mfma_f32_32x32x16_bf16 v[96:111], v[40:43], v[28:31], v[96:111]
    ds_read_b64_tr_b16 v[50:51], v21 offset:2560
    ds_read_b64_tr_b16 v[52:53], v22 offset:2048
    ds_read_b64_tr_b16 v[54:55], v22 offset:2560
    v_mfma_f32_32x32x16_bf16 v[112:127], v[44:47], v[24:27], v[112:127]
    v_mfma_f32_32x32x16_bf16 v[128:143], v[44:47], v[28:31], v[128:143]
    s_cmp_ge_u32 s26, 4
    s_cbranch_scc1 YSKIP_28
    buffer_store_dwordx4 v[72:75], v23, s[28:31], s39 offen offset:0 sc1
YSKIP_28:
    s_waitcnt lgkmcnt(0)
    s_barrier
    v_mfma_f32_32x32x16_bf16 v[80:95], v[48:51], v[32:35], v[80:95]
    ds_read_b128 v[24:27], v12 offset:16384
    ds_read_b128 v[28:31], v12 offset:20480
    ds_read_b64_tr_b16 v[40:41], v21 offset:16384
    v_mfma_f32_32x32x16_bf16 v[96:111], v[48:51], v[36:39], v[96:111]
    ds_read_b64_tr_b16 v[42:43], v21 offset:16896
    ds_read_b64_tr_b16 v[44:45], v22 offset:16384
    ds_read_b64_tr_b16 v[46:47], v22 offset:16896
    v_mfma_f32_32x32x16_bf16 v[112:127], v[52:55], v[32:35], v[112:127]
    v_mfma_f32_32x32x16_bf16 v[128:143], v[52:55], v[36:39], v[128:143]
    s_waitcnt lgkmcnt(0)
    v_mfma_f32_32x32x16_bf16 v[80:95], v[40:43], v[24:27], v[80:95]
    ds_read_b128 v[32:35], v13 offset:16384
    ds_read_b128 v[36:39], v13 offset:20480
    ds_read_b64_tr_b16 v[48:49], v21 offset:18432
    v_mfma_f32_32x32x16_bf16 v[96:111], v[40:43], v[28:31], v[96:111]
    ds_read_b64_tr_b16 v[50:51], v21 offset:18944
    ds_read_b64_tr_b16 v[52:53], v22 offset:18432
    ds_read_b64_tr_b16 v[54:55], v22 offset:18944
    v_mfma_f32_32x32x16_bf16 v[112:127], v[44:47], v[24:27], v[112:127]
    v_mfma_f32_32x32x16_bf16 v[128:143], v[44:47], v[28:31], v[128:143]
    s_cmp_ge_u32 s26, 4
    s_cbranch_scc1 YSKIP_29
    buffer_store_dwordx4 v[76:79], v23, s[28:31], s39 offen offset:1024 sc1
YSKIP_29:
    s_waitcnt lgkmcnt(0)
    s_barrier
    v_mfma_f32_32x32x16_bf16 v[80:95], v[48:51], v[32:35], v[80:95]
    ds_read_b128 v[24:27], v10 offset:32768
    ds_read_b128 v[28:31], v10 offset:36864
    ds_read_b64_tr_b16 v[40:41], v21 offset:32768
    v_mfma_f32_32x32x16_bf16 v[96:111], v[48:51], v[36:39], v[96:111]
    ds_read_b64_tr_b16 v[42:43], v21 offset:33280
    ds_read_b64_tr_b16 v[44:45], v22 offset:32768
    ds_read_b64_tr_b16 v[46:47], v22 offset:33280
    v_mfma_f32_32x32x16_bf16 v[112:127], v[52:55], v[32:35], v[112:127]
    v_mfma_f32_32x32x16_bf16 v[128:143], v[52:55], v[36:39], v[128:143]
    s_waitcnt lgkmcnt(0)
    v_mfma_f32_32x32x16_bf16 v[80:95], v[40:43], v[24:27], v[80:95]
    ds_read_b128 v[32:35], v11 offset:32768
    ds_read_b128 v[36:39], v11 offset:36864
    ds_read_b64_tr_b16 v[48:49], v21 offset:34816
    v_mfma_f32_32x32x16_bf16 v[96:111], v[40:43], v[28:31], v[96:111]
    ds_read_b64_tr_b16 v[50:51], v21 offset:35328
    ds_read_b64_tr_b16 v[52:53], v22 offset:34816
    ds_read_b64_tr_b16 v[54:55], v22 offset:35328
    v_mfma_f32_32x32x16_bf16 v[112:127], v[44:47], v[24:27], v[112:127]
    v_mfma_f32_32x32x16_bf16 v[128:143], v[44:47], v[28:31], v[128:143]
    s_waitcnt lgkmcnt(0)
    s_barrier
    v_mfma_f32_32x32x16_bf16 v[80:95], v[48:51], v[32:35], v[80:95]
    ds_read_b128 v[24:27], v12 offset:32768
    ds_read_b128 v[28:31], v12 offset:36864
    ds_read_b64_tr_b16 v[40:41], v19 offset:0
    v_mfma_f32_32x32x16_bf16 v[96:111], v[48:51], v[36:39], v[96:111]
    ds_read_b64_tr_b16 v[42:43], v19 offset:512
    ds_read_b64_tr_b16 v[44:45], v20 offset:0
    ds_read_b64_tr_b16 v[46:47], v20 offset:512
    v_mfma_f32_32x32x16_bf16 v[112:127], v[52:55], v[32:35], v[112:127]
    v_mfma_f32_32x32x16_bf16 v[128:143], v[52:55], v[36:39], v[128:143]
    s_waitcnt vmcnt(0)
    s_mov_b32 s69, 0x40000
NLOOP_30:
    v_cmp_ne_u32 vcc, 0, v164
    s_sub_u32 s69, s69, 1
    s_cbranch_scc1 NDONE_31
    s_cbranch_vccnz NDONE_31
    global_load_dwordx2 v[164:165], v152, s[22:23] sc1
    s_waitcnt vmcnt(0)
    s_branch NLOOP_30
NDONE_31:
    s_mov_b64 exec, 1
    buffer_store_dwordx2 v[164:165], off, s[28:31], s40 sc1
    buffer_store_dwordx2 v[164:165], off, s[28:31], s41 sc1
    s_mov_b64 exec, -1
    s_waitcnt lgkmcnt(0)
    v_mfma_f32_32x32x16_bf16 v[80:95], v[40:43], v[24:27], v[80:95]
    ds_read_b128 v[32:35], v13 offset:32768
    ds_read_b128 v[36:39], v13 offset:36864
    ds_read_b64_tr_b16 v[48:49], v19 offset:2048
    v_mfma_f32_32x32x16_bf16 v[96:111], v[40:43], v[28:31], v[96:111]
    ds_read_b64_tr_b16 v[50:51], v19 offset:2560
    ds_read_b64_tr_b16 v[52:53], v20 offset:2048
    ds_read_b64_tr_b16 v[54:55], v20 offset:2560
    v_mfma_f32_32x32x16_bf16 v[112:127], v[44:47], v[24:27], v[112:127]
    v_mfma_f32_32x32x16_bf16 v[128:143], v[44:47], v[28:31], v[128:143]
    s_waitcnt lgkmcnt(0)
    s_barrier
    v_mfma_f32_32x32x16_bf16 v[80:95], v[48:51], v[32:35], v[80:95]
    ds_read_b128 v[24:27], v10 offset:49152
    ds_read_b128 v[28:31], v10 offset:53248
    ds_read_b64_tr_b16 v[40:41], v21 offset:0
    v_mfma_f32_32x32x16_bf16 v[96:111], v[48:51], v[36:39], v[96:111]
    ds_read_b64_tr_b16 v[42:43], v21 offset:512
    ds_read_b64_tr_b16 v[44:45], v22 offset:0
    ds_read_b64_tr_b16 v[46:47], v22 offset:512
    v_mfma_f32_32x32x16_bf16 v[112:127], v[52:55], v[32:35], v[112:127]
    v_mfma_f32_32x32x16_bf16 v[128:143], v[52:55], v[36:39], v[128:143]
    s_waitcnt lgkmcnt(0)
    v_mfma_f32_32x32x16_bf16 v[80:95], v[40:43], v[24:27], v[80:95]
    ds_read_b128 v[32:35], v11 offset:49152
    ds_read_b128 v[36:39], v11 offset:53248
    ds_read_b64_tr_b16 v[48:49], v21 offset:2048
    v_mfma_f32_32x32x16_bf16 v[96:111], v[40:43], v[28:31], v[96:111]
    ds_read_b64_tr_b16 v[50:51], v21 offset:2560
    ds_read_b64_tr_b16 v[52:53], v22 offset:2048
    ds_read_b64_tr_b16 v[54:55], v22 offset:2560
    v_mfma_f32_32x32x16_bf16 v[112:127], v[44:47], v[24:27], v[112:127]
    v_mfma_f32_32x32x16_bf16 v[128:143], v[44:47], v[28:31], v[128:143]
    s_waitcnt lgkmcnt(0)
    s_barrier
    v_mfma_f32_32x32x16_bf16 v[80:95], v[48:51], v[32:35], v[80:95]
    ds_read_b128 v[24:27], v12 offset:49152
    ds_read_b128 v[28:31], v12 offset:53248
    ds_read_b64_tr_b16 v[40:41], v21 offset:16384
    v_mfma_f32_32x32x16_bf16 v[96:111], v[48:51], v[36:39], v[96:111]
    ds_read_b64_tr_b16 v[42:43], v21 offset:16896
    ds_read_b64_tr_b16 v[44:45], v22 offset:16384
    ds_read_b64_tr_b16 v[46:47], v22 offset:16896
    v_mfma_f32_32x32x16_bf16 v[112:127], v[52:55], v[32:35], v[112:127]
    v_mfma_f32_32x32x16_bf16 v[128:143], v[52:55], v[36:39], v[128:143]
    s_waitcnt lgkmcnt(0)
    v_mfma_f32_32x32x16_bf16 v[80:95], v[40:43], v[24:27], v[80:95]
    ds_read_b128 v[32:35], v13 offset:49152
    ds_read_b128 v[36:39], v13 offset:53248
    ds_read_b64_tr_b16 v[48:49], v21 offset:18432
    v_mfma_f32_32x32x16_bf16 v[96:111], v[40:43], v[28:31], v[96:111]
    ds_read_b64_tr_b16 v[50:51], v21 offset:18944
    ds_read_b64_tr_b16 v[52:53], v22 offset:18432
    ds_read_b64_tr_b16 v[54:55], v22 offset:18944
    v_mfma_f32_32x32x16_bf16 v[112:127], v[44:47], v[24:27], v[112:127]
    v_mfma_f32_32x32x16_bf16 v[128:143], v[44:47], v[28:31], v[128:143]
    s_waitcnt lgkmcnt(0)
    s_barrier
    v_mfma_f32_32x32x16_bf16 v[80:95], v[48:51], v[32:35], v[80:95]
    ds_read_b128 v[24:27], v14 offset:0
    ds_read_b128 v[28:31], v14 offset:4096
    ds_read_b64_tr_b16 v[40:41], v19 offset:16384
    v_mfma_f32_32x32x16_bf16 v[96:111], v[48:51], v[36:39], v[96:111]
    ds_read_b64_tr_b16 v[42:43], v19 offset:16896
    ds_read_b64_tr_b16 v[44:45], v20 offset:16384
    ds_read_b64_tr_b16 v[46:47], v20 offset:16896
    v_mfma_f32_32x32x16_bf16 v[112:127], v[52:55], v[32:35], v[112:127]
    v_mfma_f32_32x32x16_bf16 v[128:143], v[52:55], v[36:39], v[128:143]
    s_waitcnt lgkmcnt(0)
    v_mfma_f32_32x32x16_bf16 v[80:95], v[40:43], v[24:27], v[80:95]
    ds_read_b128 v[32:35], v15 offset:0
    ds_read_b128 v[36:39], v15 offset:4096
    ds_read_b64_tr_b16 v[48:49], v19 offset:18432
    v_mfma_f32_32x32x16_bf16 v[96:111], v[40:43], v[28:31], v[96:111]
    ds_read_b64_tr_b16 v[50:51], v19 offset:18944
    ds_read_b64_tr_b16 v[52:53], v20 offset:18432
    ds_read_b64_tr_b16 v[54:55], v20 offset:18944
    v_mfma_f32_32x32x16_bf16 v[112:127], v[44:47], v[24:27], v[112:127]
    v_mfma_f32_32x32x16_bf16 v[128:143], v[44:47], v[28:31], v[128:143]
    s_waitcnt lgkmcnt(0)
    v_mfma_f32_32x32x16_bf16 v[80:95], v[48:51], v[32:35], v[80:95]
    ds_read_b128 v[24:27], v16 offset:0
    ds_read_b128 v[28:31], v16 offset:4096
    ds_read_b64_tr_b16 v[40:41], v21 offset:32768
    v_mfma_f32_32x32x16_bf16 v[96:111], v[48:51], v[36:39], v[96:111]
    ds_read_b64_tr_b16 v[42:43], v21 offset:33280
    ds_read_b64_tr_b16 v[44:45], v22 offset:32768
    ds_read_b64_tr_b16 v[46:47], v22 offset:33280
    v_mfma_f32_32x32x16_bf16 v[112:127], v[52:55], v[32:35], v[112:127]
    v_mfma_f32_32x32x16_bf16 v[128:143], v[52:55], v[36:39], v[128:143]
    s_waitcnt lgkmcnt(0)
    v_mfma_f32_32x32x16_bf16 v[80:95], v[40:43], v[24:27], v[80:95]
    ds_read_b128 v[32:35], v17 offset:0
    ds_read_b128 v[36:39], v17 offset:4096
    ds_read_b64_tr_b16 v[48:49], v21 offset:34816
    v_mfma_f32_32x32x16_bf16 v[96:111], v[40:43], v[28:31], v[96:111]
    ds_read_b64_tr_b16 v[50:51], v21 offset:35328
    ds_read_b64_tr_b16 v[52:53], v22 offset:34816
    ds_read_b64_tr_b16 v[54:55], v22 offset:35328
    v_mfma_f32_32x32x16_bf16 v[112:127], v[44:47], v[24:27], v[112:127]
    v_mfma_f32_32x32x16_bf16 v[128:143], v[44:47], v[28:31], v[128:143]
    s_waitcnt lgkmcnt(0)
    s_barrier
    v_mfma_f32_32x32x16_bf16 v[80:95], v[48:51], v[32:35], v[80:95]
    ds_read_b128 v[24:27], v14 offset:16384
    ds_read_b128 v[28:31], v14 offset:20480
    ds_read_b64_tr_b16 v[40:41], v19 offset:32768
    v_mfma_f32_32x32x16_bf16 v[96:111], v[48:51], v[36:39], v[96:111]
    ds_read_b64_tr_b16 v[42:43], v19 offset:33280
    ds_read_b64_tr_b16 v[44:45], v20 offset:32768
    ds_read_b64_tr_b16 v[46:47], v20 offset:33280
    v_mfma_f32_32x32x16_bf16 v[112:127], v[52:55], v[32:35], v[112:127]
    v_mfma_f32_32x32x16_bf16 v[128:143], v[52:55], v[36:39], v[128:143]
    s_sub_u32 s3, 1, s62
    s_cbranch_scc1 P2_NOPRIO
    s_cmp_eq_u32 s62, 1
    s_cbranch_scc1 P2_NOPRIO
    s_setprio 2
P2_NOPRIO:
    s_waitcnt lgkmcnt(0)
    v_mfma_f32_32x32x16_bf16 v[80:95], v[40:43], v[24:27], v[80:95]
    ds_read_b128 v[32:35], v15 offset:16384
    ds_read_b128 v[36:39], v15 offset:20480
    ds_read_b64_tr_b16 v[48:49], v19 offset:34816
    v_mfma_f32_32x32x16_bf16 v[96:111], v[40:43], v[28:31], v[96:111]
    ds_read_b64_tr_b16 v[50:51], v19 offset:35328
    ds_read_b64_tr_b16 v[52:53], v20 offset:34816
    ds_read_b64_tr_b16 v[54:55], v20 offset:35328
    v_mfma_f32_32x32x16_bf16 v[112:127], v[44:47], v[24:27], v[112:127]
    v_mfma_f32_32x32x16_bf16 v[128:143], v[44:47], v[28:31], v[128:143]
    s_waitcnt lgkmcnt(0)
    v_mfma_f32_32x32x16_bf16 v[80:95], v[48:51], v[32:35], v[80:95]
    ds_read_b128 v[24:27], v16 offset:16384
    ds_read_b128 v[28:31], v16 offset:20480
    ds_read_b64_tr_b16 v[40:41], v21 offset:0
    v_mfma_f32_32x32x16_bf16 v[96:111], v[48:51], v[36:39], v[96:111]
    ds_read_b64_tr_b16 v[42:43], v21 offset:512
    ds_read_b64_tr_b16 v[44:45], v22 offset:0
    ds_read_b64_tr_b16 v[46:47], v22 offset:512
    v_mfma_f32_32x32x16_bf16 v[112:127], v[52:55], v[32:35], v[112:127]
    v_mfma_f32_32x32x16_bf16 v[128:143], v[52:55], v[36:39], v[128:143]
    s_waitcnt lgkmcnt(0)
    v_mfma_f32_32x32x16_bf16 v[80:95], v[40:43], v[24:27], v[80:95]
    ds_read_b128 v[32:35], v17 offset:16384
    ds_read_b128 v[36:39], v17 offset:20480
    ds_read_b64_tr_b16 v[48:49], v21 offset:2048
    v_mfma_f32_32x32x16_bf16 v[96:111], v[40:43], v[28:31], v[96:111]
    ds_read_b64_tr_b16 v[50:51], v21 offset:2560
    ds_read_b64_tr_b16 v[52:53], v22 offset:2048
    ds_read_b64_tr_b16 v[54:55], v22 offset:2560
    v_mfma_f32_32x32x16_bf16 v[112:127], v[44:47], v[24:27], v[112:127]
    v_mfma_f32_32x32x16_bf16 v[128:143], v[44:47], v[28:31], v[128:143]
    s_waitcnt lgkmcnt(0)
    v_mfma_f32_32x32x16_bf16 v[80:95], v[48:51], v[32:35], v[80:95]
    ds_read_b128 v[24:27], v14 offset:32768
    ds_read_b128 v[28:31], v14 offset:36864
    ds_read_b64_tr_b16 v[40:41], v21 offset:16384
    v_mfma_f32_32x32x16_bf16 v[96:111], v[48:51], v[36:39], v[96:111]
    ds_read_b64_tr_b16 v[42:43], v21 offset:16896
    ds_read_b64_tr_b16 v[44:45], v22 offset:16384
    ds_read_b64_tr_b16 v[46:47], v22 offset:16896
    v_mfma_f32_32x32x16_bf16 v[112:127], v[52:55], v[32:35], v[112:127]
    v_mfma_f32_32x32x16_bf16 v[128:143], v[52:55], v[36:39], v[128:143]
    s_waitcnt lgkmcnt(0)
    v_mfma_f32_32x32x16_bf16 v[80:95], v[40:43], v[24:27], v[80:95]
    ds_read_b128 v[32:35], v15 offset:32768
    ds_read_b128 v[36:39], v15 offset:36864
    ds_read_b64_tr_b16 v[48:49], v21 offset:18432
    v_mfma_f32_32x32x16_bf16 v[96:111], v[40:43], v[28:31], v[96:111]
    ds_read_b64_tr_b16 v[50:51], v21 offset:18944
    ds_read_b64_tr_b16 v[52:53], v22 offset:18432
    ds_read_b64_tr_b16 v[54:55], v22 offset:18944
    v_mfma_f32_32x32x16_bf16 v[112:127], v[44:47], v[24:27], v[112:127]
    v_mfma_f32_32x32x16_bf16 v[128:143], v[44:47], v[28:31], v[128:143]
    s_waitcnt lgkmcnt(0)
    v_mfma_f32_32x32x16_bf16 v[80:95], v[48:51], v[32:35], v[80:95]
    ds_read_b128 v[24:27], v16 offset:32768
    ds_read_b128 v[28:31], v16 offset:36864
    ds_read_b64_tr_b16 v[40:41], v19 offset:49152
    v_mfma_f32_32x32x16_bf16 v[96:111], v[48:51], v[36:39], v[96:111]
    ds_read_b64_tr_b16 v[42:43], v19 offset:49664
    ds_read_b64_tr_b16 v[44:45], v20 offset:49152
    ds_read_b64_tr_b16 v[46:47], v20 offset:49664
    v_mfma_f32_32x32x16_bf16 v[112:127], v[52:55], v[32:35], v[112:127]
    v_mfma_f32_32x32x16_bf16 v[128:143], v[52:55], v[36:39], v[128:143]
    s_waitcnt lgkmcnt(0)
    v_mfma_f32_32x32x16_bf16 v[80:95], v[40:43], v[24:27], v[80:95]
    ds_read_b128 v[32:35], v17 offset:32768
    ds_read_b128 v[36:39], v17 offset:36864
    ds_read_b64_tr_b16 v[48:49], v19 offset:51200
    v_mfma_f32_32x32x16_bf16 v[96:111], v[40:43], v[28:31], v[96:111]
    ds_read_b64_tr_b16 v[50:51], v19 offset:51712
    ds_read_b64_tr_b16 v[52:53], v20 offset:51200
    ds_read_b64_tr_b16 v[54:55], v20 offset:51712
    v_mfma_f32_32x32x16_bf16 v[112:127], v[44:47], v[24:27], v[112:127]
    v_mfma_f32_32x32x16_bf16 v[128:143], v[44:47], v[28:31], v[128:143]
    s_waitcnt lgkmcnt(0)
    v_mfma_f32_32x32x16_bf16 v[80:95], v[48:51], v[32:35], v[80:95]
    v_mfma_f32_32x32x16_bf16 v[96:111], v[48:51], v[36:39], v[96:111]
    v_mfma_f32_32x32x16_bf16 v[112:127], v[52:55], v[32:35], v[112:127]
    v_mfma_f32_32x32x16_bf16 v[128:143], v[52:55], v[36:39], v[128:143]
    s_lshl_b32 s65, s56, 1
    s_and_b32 s3, s26, 1
    s_add_u32 s65, s65, s3
    s_lshl_b32 s63, s57, 2
    s_lshr_b32 s3, s26, 1
    s_add_u32 s63, s63, s3
    s_mul_i32 s40, s65, 112
    s_add_u32 s40, s40, s63
    s_lshl_b32 s40, s40, 11
    s_add_u32 s40, s40, 6291456
    s_add_u32 s42, s40, 114688
    s_mul_i32 s44, s63, 37
    s_lshr_b32 s44, s44, 9
    s_mul_i32 s45, s44, 14
    s_sub_u32 s45, s63, s45
    s_lshl_b32 s59, s65, 2
    s_add_u32 s59, s59, s44
    s_mul_i32 s59, s59, 4352
    s_lshl_b32 s45, s45, 3
    s_add_u32 s59, s59, s45
    s_add_u32 s59, s59, 22507520
    v_mov_b32 v10, 0xbdd2d3e8
    v_mov_b32 v11, 0xbdd2d3e8
    v_mov_b32 v12, 0xc0135761
    v_mov_b32 v13, 0xc0135761
    v_mov_b32 v14, 1.0
    v_mov_b32 v15, 1.0
    s_cmp_eq_u32 s62, 1
    s_cbranch_scc1 P2_GELY
    s_setprio 0
    v_mul_f32 v24, v80, v80
    v_mul_f32 v25, v81, v81
    v_mul_f32 v26, v82, v82
    v_mul_f32 v27, v83, v83
    v_mul_f32 v28, v84, v84
    v_mul_f32 v29, v85, v85
    v_mul_f32 v30, v86, v86
    v_mul_f32 v31, v87, v87
    v_fma_f32 v24, v24, v10, v12
    v_fma_f32 v25, v25, v10, v12
    v_fma_f32 v26, v26, v10, v12
    v_fma_f32 v27, v27, v10, v12
    v_fma_f32 v28, v28, v10, v12
    v_fma_f32 v29, v29, v10, v12
    v_fma_f32 v30, v30, v10, v12
    v_fma_f32 v31, v31, v10, v12
    v_mul_f32 v24, v24, v80
    v_mul_f32 v25, v25, v81
    v_mul_f32 v26, v26, v82
    v_mul_f32 v27, v27, v83
    v_mul_f32 v28, v28, v84
    v_mul_f32 v29, v29, v85
    v_mul_f32 v30, v30, v86
    v_mul_f32 v31, v31, v87
    v_exp_f32 v24, v24
    v_exp_f32 v25, v25
    v_exp_f32 v26, v26
    v_exp_f32 v27, v27
    v_exp_f32 v28, v28
    v_exp_f32 v29, v29
    v_exp_f32 v30, v30
    v_exp_f32 v31, v31
    v_mul_f32 v32, v80, v88
    v_mul_f32 v33, v81, v89
    v_mul_f32 v34, v82, v90
    v_mul_f32 v35, v83, v91
    v_mul_f32 v36, v84, v92
    v_mul_f32 v37, v85, v93
    v_mul_f32 v38, v86, v94
    v_mul_f32 v39, v87, v95
    v_add_f32 v24, 1.0, v24
    v_add_f32 v25, 1.0, v25
    v_add_f32 v26, 1.0, v26
    v_add_f32 v27, 1.0, v27
    v_add_f32 v28, 1.0, v28
    v_add_f32 v29, 1.0, v29
    v_add_f32 v30, 1.0, v30
    v_add_f32 v31, 1.0, v31
    v_rcp_f32 v24, v24
    v_rcp_f32 v25, v25
    v_rcp_f32 v26, v26
    v_rcp_f32 v27, v27
    v_rcp_f32 v28, v28
    v_rcp_f32 v29, v29
    v_rcp_f32 v30, v30
    v_rcp_f32 v31, v31
    s_nop 0
    v_mul_f32 v24, v24, v32
    v_mul_f32 v25, v25, v33
    v_mul_f32 v26, v26, v34
    v_mul_f32 v27, v27, v35
    v_mul_f32 v28, v28, v36
    v_mul_f32 v29, v29, v37
    v_mul_f32 v30, v30, v38
    v_mul_f32 v31, v31, v39
    v_cvt_pk_bf16_f32 v144, v24, v25
    v_cvt_pk_bf16_f32 v145, v26, v27
    v_cvt_pk_bf16_f32 v146, v28, v29
    v_cvt_pk_bf16_f32 v147, v30, v31
    v_mul_f32 v24, v96, v96
    v_mul_f32 v25, v97, v97
    v_mul_f32 v26, v98, v98
    v_mul_f32 v27, v99, v99
    v_mul_f32 v28, v100, v100
    v_mul_f32 v29, v101, v101
    v_mul_f32 v30, v102, v102
    v_mul_f32 v31, v103, v103
    v_fma_f32 v24, v24, v10, v12
    v_fma_f32 v25, v25, v10, v12
    v_fma_f32 v26, v26, v10, v12
    v_fma_f32 v27, v27, v10, v12
    v_fma_f32 v28, v28, v10, v12
    v_fma_f32 v29, v29, v10, v12
    v_fma_f32 v30, v30, v10, v12
    v_fma_f32 v31, v31, v10, v12
    v_mul_f32 v24, v24, v96
    v_mul_f32 v25, v25, v97
    v_mul_f32 v26, v26, v98
    v_mul_f32 v27, v27, v99
    v_mul_f32 v28, v28, v100
    v_mul_f32 v29, v29, v101
    v_mul_f32 v30, v30, v102
    v_mul_f32 v31, v31, v103
    v_exp_f32 v24, v24
    v_exp_f32 v25, v25
    v_exp_f32 v26, v26
    v_exp_f32 v27, v27
    v_exp_f32 v28, v28
    v_exp_f32 v29, v29
    v_exp_f32 v30, v30
    v_exp_f32 v31, v31
    v_mul_f32 v32, v96, v104
    v_mul_f32 v33, v97, v105
    v_mul_f32 v34, v98, v106
    v_mul_f32 v35, v99, v107
    v_mul_f32 v36, v100, v108
    v_mul_f32 v37, v101, v109
    v_mul_f32 v38, v102, v110
    v_mul_f32 v39, v103, v111
    v_add_f32 v24, 1.0, v24
    v_add_f32 v25, 1.0, v25
    v_add_f32 v26, 1.0, v26
    v_add_f32 v27, 1.0, v27
    v_add_f32 v28, 1.0, v28
    v_add_f32 v29, 1.0, v29
    v_add_f32 v30, 1.0, v30
    v_add_f32 v31, 1.0, v31
    v_rcp_f32 v24, v24
    v_rcp_f32 v25, v25
    v_rcp_f32 v26, v26
    v_rcp_f32 v27, v27
    v_rcp_f32 v28, v28
    v_rcp_f32 v29, v29
    v_rcp_f32 v30, v30
    v_rcp_f32 v31, v31
    s_nop 0
    v_mul_f32 v24, v24, v32
    v_mul_f32 v25, v25, v33
    v_mul_f32 v26, v26, v34
    v_mul_f32 v27, v27, v35
    v_mul_f32 v28, v28, v36
    v_mul_f32 v29, v29, v37
    v_mul_f32 v30, v30, v38
    v_mul_f32 v31, v31, v39
    v_cvt_pk_bf16_f32 v152, v24, v25
    v_cvt_pk_bf16_f32 v153, v26, v27
    v_cvt_pk_bf16_f32 v154, v28, v29
    v_cvt_pk_bf16_f32 v155, v30, v31
    v_mul_f32 v24, v112, v112
    v_mul_f32 v25, v113, v113
    v_mul_f32 v26, v114, v114
    v_mul_f32 v27, v115, v115
    v_mul_f32 v28, v116, v116
    v_mul_f32 v29, v117, v117
    v_mul_f32 v30, v118, v118
    v_mul_f32 v31, v119, v119
    v_fma_f32 v24, v24, v10, v12
    v_fma_f32 v25, v25, v10, v12
    v_fma_f32 v26, v26, v10, v12
    v_fma_f32 v27, v27, v10, v12
    v_fma_f32 v28, v28, v10, v12
    v_fma_f32 v29, v29, v10, v12
    v_fma_f32 v30, v30, v10, v12
    v_fma_f32 v31, v31, v10, v12
    v_mul_f32 v24, v24, v112
    v_mul_f32 v25, v25, v113
    v_mul_f32 v26, v26, v114
    v_mul_f32 v27, v27, v115
    v_mul_f32 v28, v28, v116
    v_mul_f32 v29, v29, v117
    v_mul_f32 v30, v30, v118
    v_mul_f32 v31, v31, v119
    v_exp_f32 v24, v24
    v_exp_f32 v25, v25
    v_exp_f32 v26, v26
    v_exp_f32 v27, v27
    v_exp_f32 v28, v28
    v_exp_f32 v29, v29
    v_exp_f32 v30, v30
    v_exp_f32 v31, v31
    v_mul_f32 v32, v112, v120
    v_mul_f32 v33, v113, v121
    v_mul_f32 v34, v114, v122
    v_mul_f32 v35, v115, v123
    v_mul_f32 v36, v116, v124
    v_mul_f32 v37, v117, v125
    v_mul_f32 v38, v118, v126
    v_mul_f32 v39, v119, v127
    v_add_f32 v24, 1.0, v24
    v_add_f32 v25, 1.0, v25
    v_add_f32 v26, 1.0, v26
    v_add_f32 v27, 1.0, v27
    v_add_f32 v28, 1.0, v28
    v_add_f32 v29, 1.0, v29
    v_add_f32 v30, 1.0, v30
    v_add_f32 v31, 1.0, v31
    v_rcp_f32 v24, v24
    v_rcp_f32 v25, v25
    v_rcp_f32 v26, v26
    v_rcp_f32 v27, v27
    v_rcp_f32 v28, v28
    v_rcp_f32 v29, v29
    v_rcp_f32 v30, v30
    v_rcp_f32 v31, v31
    s_nop 0
    v_mul_f32 v24, v24, v32
    v_mul_f32 v25, v25, v33
    v_mul_f32 v26, v26, v34
    v_mul_f32 v27, v27, v35
    v_mul_f32 v28, v28, v36
    v_mul_f32 v29, v29, v37
    v_mul_f32 v30, v30, v38
    v_mul_f32 v31, v31, v39
    v_cvt_pk_bf16_f32 v148, v24, v25
    v_cvt_pk_bf16_f32 v149, v26, v27
    v_cvt_pk_bf16_f32 v150, v28, v29
    v_cvt_pk_bf16_f32 v151, v30, v31
    s_barrier
    v_pk_mul_f32 v[24:25], v[128:129], v[128:129]
    v_pk_mul_f32 v[26:27], v[130:131], v[130:131]
    v_pk_mul_f32 v[28:29], v[132:133], v[132:133]
    v_pk_mul_f32 v[30:31], v[134:135], v[134:135]
    v_pk_fma_f32 v[24:25], v[24:25], v[10:11], v[12:13]
    v_pk_fma_f32 v[26:27], v[26:27], v[10:11], v[12:13]
    v_pk_fma_f32 v[28:29], v[28:29], v[10:11], v[12:13]
    v_pk_fma_f32 v[30:31], v[30:31], v[10:11], v[12:13]
    v_pk_mul_f32 v[24:25], v[24:25], v[128:129]
    v_pk_mul_f32 v[26:27], v[26:27], v[130:131]
    v_pk_mul_f32 v[28:29], v[28:29], v[132:133]
    v_pk_mul_f32 v[30:31], v[30:31], v[134:135]
    v_exp_f32 v24, v24
    v_exp_f32 v25, v25
    v_exp_f32 v26, v26
    v_exp_f32 v27, v27
    v_exp_f32 v28, v28
    v_exp_f32 v29, v29
    v_exp_f32 v30, v30
    v_exp_f32 v31, v31
    v_pk_mul_f32 v[32:33], v[128:129], v[136:137]
    v_pk_mul_f32 v[34:35], v[130:131], v[138:139]
    v_pk_mul_f32 v[36:37], v[132:133], v[140:141]
    v_pk_mul_f32 v[38:39], v[134:135], v[142:143]
    v_pk_add_f32 v[24:25], v[24:25], v[14:15]
    v_pk_add_f32 v[26:27], v[26:27], v[14:15]
    v_pk_add_f32 v[28:29], v[28:29], v[14:15]
    v_pk_add_f32 v[30:31], v[30:31], v[14:15]
    v_rcp_f32 v24, v24
    v_rcp_f32 v25, v25
    v_rcp_f32 v26, v26
    v_rcp_f32 v27, v27
    v_rcp_f32 v28, v28
    v_rcp_f32 v29, v29
    v_rcp_f32 v30, v30
    v_rcp_f32 v31, v31
    s_nop 0
    v_pk_mul_f32 v[24:25], v[24:25], v[32:33]
    v_pk_mul_f32 v[26:27], v[26:27], v[34:35]
    v_pk_mul_f32 v[28:29], v[28:29], v[36:37]
    v_pk_mul_f32 v[30:31], v[30:31], v[38:39]
    v_cvt_pk_bf16_f32 v156, v24, v25
    v_cvt_pk_bf16_f32 v157, v26, v27
    v_cvt_pk_bf16_f32 v158, v28, v29
    v_cvt_pk_bf16_f32 v159, v30, v31
    buffer_store_dwordx4 v[144:147], v9, s[28:31], s40 offen offset:0 sc1
    buffer_store_dwordx4 v[152:155], v9, s[28:31], s42 offen offset:0 sc1
    buffer_store_dwordx4 v[148:151], v9, s[28:31], s40 offen offset:1024 sc1
    buffer_store_dwordx4 v[156:159], v9, s[28:31], s42 offen offset:1024 sc1
    s_branch P1_DONE
P2_GELY:
    v_pk_mul_f32 v[24:25], v[80:81], v[80:81]
    v_pk_mul_f32 v[26:27], v[82:83], v[82:83]
    v_pk_mul_f32 v[28:29], v[84:85], v[84:85]
    v_pk_mul_f32 v[30:31], v[86:87], v[86:87]
    v_pk_fma_f32 v[24:25], v[24:25], v[10:11], v[12:13]
    v_pk_fma_f32 v[26:27], v[26:27], v[10:11], v[12:13]
    v_pk_fma_f32 v[28:29], v[28:29], v[10:11], v[12:13]
    v_pk_fma_f32 v[30:31], v[30:31], v[10:11], v[12:13]
    v_pk_mul_f32 v[24:25], v[24:25], v[80:81]
    v_pk_mul_f32 v[26:27], v[26:27], v[82:83]
    v_pk_mul_f32 v[28:29], v[28:29], v[84:85]
    v_pk_mul_f32 v[30:31], v[30:31], v[86:87]
    v_exp_f32 v24, v24
    v_exp_f32 v25, v25
    v_exp_f32 v26, v26
    v_exp_f32 v27, v27
    v_exp_f32 v28, v28
    v_exp_f32 v29, v29
    v_exp_f32 v30, v30
    v_exp_f32 v31, v31
    v_pk_mul_f32 v[32:33], v[80:81], v[88:89]
    v_pk_mul_f32 v[34:35], v[82:83], v[90:91]
    v_pk_mul_f32 v[36:37], v[84:85], v[92:93]
    v_pk_mul_f32 v[38:39], v[86:87], v[94:95]
    v_pk_add_f32 v[24:25], v[24:25], v[14:15]
    v_pk_add_f32 v[26:27], v[26:27], v[14:15]
    v_pk_add_f32 v[28:29], v[28:29], v[14:15]
    v_pk_add_f32 v[30:31], v[30:31], v[14:15]
    v_rcp_f32 v24, v24
    v_rcp_f32 v25, v25
    v_rcp_f32 v26, v26
    v_rcp_f32 v27, v27
    v_rcp_f32 v28, v28
    v_rcp_f32 v29, v29
    v_rcp_f32 v30, v30
    v_rcp_f32 v31, v31
    s_nop 0
    v_pk_mul_f32 v[24:25], v[24:25], v[32:33]
    v_pk_mul_f32 v[26:27], v[26:27], v[34:35]
    v_pk_mul_f32 v[28:29], v[28:29], v[36:37]
    v_pk_mul_f32 v[30:31], v[30:31], v[38:39]
    v_cvt_pk_bf16_f32 v144, v24, v25
    v_cvt_pk_bf16_f32 v145, v26, v27
    v_cvt_pk_bf16_f32 v146, v28, v29
    v_cvt_pk_bf16_f32 v147, v30, v31
    s_barrier
    v_pk_mul_f32 v[24:25], v[96:97], v[96:97]
    v_pk_mul_f32 v[26:27], v[98:99], v[98:99]
    v_pk_mul_f32 v[28:29], v[100:101], v[100:101]
    v_pk_mul_f32 v[30:31], v[102:103], v[102:103]
    v_pk_fma_f32 v[24:25], v[24:25], v[10:11], v[12:13]
    v_pk_fma_f32 v[26:27], v[26:27], v[10:11], v[12:13]
    v_pk_fma_f32 v[28:29], v[28:29], v[10:11], v[12:13]
    v_pk_fma_f32 v[30:31], v[30:31], v[10:11], v[12:13]
    v_pk_mul_f32 v[24:25], v[24:25], v[96:97]
    v_pk_mul_f32 v[26:27], v[26:27], v[98:99]
    v_pk_mul_f32 v[28:29], v[28:29], v[100:101]
    v_pk_mul_f32 v[30:31], v[30:31], v[102:103]
    v_exp_f32 v24, v24
    v_exp_f32 v25, v25
    v_exp_f32 v26, v26
    v_exp_f32 v27, v27
    v_exp_f32 v28, v28
    v_exp_f32 v29, v29
    v_exp_f32 v30, v30
    v_exp_f32 v31, v31
    v_pk_mul_f32 v[32:33], v[96:97], v[104:105]
    v_pk_mul_f32 v[34:35], v[98:99], v[106:107]
    v_pk_mul_f32 v[36:37], v[100:101], v[108:109]
    v_pk_mul_f32 v[38:39], v[102:103], v[110:111]
    v_pk_add_f32 v[24:25], v[24:25], v[14:15]
    v_pk_add_f32 v[26:27], v[26:27], v[14:15]
    v_pk_add_f32 v[28:29], v[28:29], v[14:15]
    v_pk_add_f32 v[30:31], v[30:31], v[14:15]
    v_rcp_f32 v24, v24
    v_rcp_f32 v25, v25
    v_rcp_f32 v26, v26
    v_rcp_f32 v27, v27
    v_rcp_f32 v28, v28
    v_rcp_f32 v29, v29
    v_rcp_f32 v30, v30
    v_rcp_f32 v31, v31
    s_nop 0
    v_pk_mul_f32 v[24:25], v[24:25], v[32:33]
    v_pk_mul_f32 v[26:27], v[26:27], v[34:35]
    v_pk_mul_f32 v[28:29], v[28:29], v[36:37]
    v_pk_mul_f32 v[30:31], v[30:31], v[38:39]
    v_cvt_pk_bf16_f32 v152, v24, v25
    v_cvt_pk_bf16_f32 v153, v26, v27
    v_cvt_pk_bf16_f32 v154, v28, v29
    v_cvt_pk_bf16_f32 v155, v30, v31
    v_pk_mul_f32 v[24:25], v[112:113], v[112:113]
    v_pk_mul_f32 v[26:27], v[114:115], v[114:115]
    v_pk_mul_f32 v[28:29], v[116:117], v[116:117]
    v_pk_mul_f32 v[30:31], v[118:119], v[118:119]
    v_pk_fma_f32 v[24:25], v[24:25], v[10:11], v[12:13]
    v_pk_fma_f32 v[26:27], v[26:27], v[10:11], v[12:13]
    v_pk_fma_f32 v[28:29], v[28:29], v[10:11], v[12:13]
    v_pk_fma_f32 v[30:31], v[30:31], v[10:11], v[12:13]
    v_pk_mul_f32 v[24:25], v[24:25], v[112:113]
    v_pk_mul_f32 v[26:27], v[26:27], v[114:115]
    v_pk_mul_f32 v[28:29], v[28:29], v[116:117]
    v_pk_mul_f32 v[30:31], v[30:31], v[118:119]
    v_exp_f32 v24, v24
    v_exp_f32 v25, v25
    v_exp_f32 v26, v26
    v_exp_f32 v27, v27
    v_exp_f32 v28, v28
    v_exp_f32 v29, v29
    v_exp_f32 v30, v30
    v_exp_f32 v31, v31
    v_pk_mul_f32 v[32:33], v[112:113], v[120:121]
    v_pk_mul_f32 v[34:35], v[114:115], v[122:123]
    v_pk_mul_f32 v[36:37], v[116:117], v[124:125]
    v_pk_mul_f32 v[38:39], v[118:119], v[126:127]
    v_pk_add_f32 v[24:25], v[24:25], v[14:15]
    v_pk_add_f32 v[26:27], v[26:27], v[14:15]
    v_pk_add_f32 v[28:29], v[28:29], v[14:15]
    v_pk_add_f32 v[30:31], v[30:31], v[14:15]
    v_rcp_f32 v24, v24
    v_rcp_f32 v25, v25
    v_rcp_f32 v26, v26
    v_rcp_f32 v27, v27
    v_rcp_f32 v28, v28
    v_rcp_f32 v29, v29
    v_rcp_f32 v30, v30
    v_rcp_f32 v31, v31
    s_nop 0
    v_pk_mul_f32 v[24:25], v[24:25], v[32:33]
    v_pk_mul_f32 v[26:27], v[26:27], v[34:35]
    v_pk_mul_f32 v[28:29], v[28:29], v[36:37]
    v_pk_mul_f32 v[30:31], v[30:31], v[38:39]
    v_cvt_pk_bf16_f32 v148, v24, v25
    v_cvt_pk_bf16_f32 v149, v26, v27
    v_cvt_pk_bf16_f32 v150, v28, v29
    v_cvt_pk_bf16_f32 v151, v30, v31
    v_pk_mul_f32 v[24:25], v[128:129], v[128:129]
    v_pk_mul_f32 v[26:27], v[130:131], v[130:131]
    v_pk_mul_f32 v[28:29], v[132:133], v[132:133]
    v_pk_mul_f32 v[30:31], v[134:135], v[134:135]
    v_pk_fma_f32 v[24:25], v[24:25], v[10:11], v[12:13]
    v_pk_fma_f32 v[26:27], v[26:27], v[10:11], v[12:13]
    v_pk_fma_f32 v[28:29], v[28:29], v[10:11], v[12:13]
    v_pk_fma_f32 v[30:31], v[30:31], v[10:11], v[12:13]
    v_pk_mul_f32 v[24:25], v[24:25], v[128:129]
    v_pk_mul_f32 v[26:27], v[26:27], v[130:131]
    v_pk_mul_f32 v[28:29], v[28:29], v[132:133]
    v_pk_mul_f32 v[30:31], v[30:31], v[134:135]
    v_exp_f32 v24, v24
    v_exp_f32 v25, v25
    v_exp_f32 v26, v26
    v_exp_f32 v27, v27
    v_exp_f32 v28, v28
    v_exp_f32 v29, v29
    v_exp_f32 v30, v30
    v_exp_f32 v31, v31
    v_pk_mul_f32 v[32:33], v[128:129], v[136:137]
    v_pk_mul_f32 v[34:35], v[130:131], v[138:139]
    v_pk_mul_f32 v[36:37], v[132:133], v[140:141]
    v_pk_mul_f32 v[38:39], v[134:135], v[142:143]
    v_pk_add_f32 v[24:25], v[24:25], v[14:15]
    v_pk_add_f32 v[26:27], v[26:27], v[14:15]
    v_pk_add_f32 v[28:29], v[28:29], v[14:15]
    v_pk_add_f32 v[30:31], v[30:31], v[14:15]
    v_rcp_f32 v24, v24
    v_rcp_f32 v25, v25
    v_rcp_f32 v26, v26
    v_rcp_f32 v27, v27
    v_rcp_f32 v28, v28
    v_rcp_f32 v29, v29
    v_rcp_f32 v30, v30
    v_rcp_f32 v31, v31
    s_nop 0
    v_pk_mul_f32 v[24:25], v[24:25], v[32:33]
    v_pk_mul_f32 v[26:27], v[26:27], v[34:35]
    v_pk_mul_f32 v[28:29], v[28:29], v[36:37]
    v_pk_mul_f32 v[30:31], v[30:31], v[38:39]
    v_cvt_pk_bf16_f32 v156, v24, v25
    v_cvt_pk_bf16_f32 v157, v26, v27
    v_cvt_pk_bf16_f32 v158, v28, v29
    v_cvt_pk_bf16_f32 v159, v30, v31
    s_branch P1_DONE
P2_IDLE:
    buffer_store_dwordx4 v[56:59], v23, s[28:31], s38 offen offset:0 sc1
    buffer_store_dwordx4 v[60:63], v23, s[28:31], s38 offen offset:1024 sc1
    s_cmp_ge_u32 s26, 4
    s_cbranch_scc1 YSKIP_32
    buffer_store_dwordx4 v[72:75], v23, s[28:31], s39 offen offset:0 sc1
YSKIP_32:
    s_cmp_ge_u32 s26, 4
    s_cbranch_scc1 YSKIP_33
    buffer_store_dwordx4 v[76:79], v23, s[28:31], s39 offen offset:1024 sc1
YSKIP_33:
    s_waitcnt vmcnt(0)
    s_mov_b32 s69, 0x40000
NLOOP_34:
    v_cmp_ne_u32 vcc, 0, v164
    s_sub_u32 s69, s69, 1
    s_cbranch_scc1 NDONE_35
    s_cbranch_vccnz NDONE_35
    global_load_dwordx2 v[164:165], v152, s[22:23] sc1
    s_waitcnt vmcnt(0)
    s_branch NLOOP_34
NDONE_35:
    s_mov_b64 exec, 1
    buffer_store_dwordx2 v[164:165], off, s[28:31], s40 sc1
    buffer_store_dwordx2 v[164:165], off, s[28:31], s41 sc1
    s_mov_b64 exec, -1
    s_waitcnt lgkmcnt(0)
    s_cmp_lt_u32 s26, 2
    s_cbranch_scc1 P2_GATE
    s_mov_b32 s32, s16
    s_and_b32 s33, s17, 0xffff
    s_mov_b32 s34, 1605632
    s_mov_b32 s35, 0x20000
    s_mov_b32 s44, s8
    s_and_b32 s45, s9, 0xffff
    s_mov_b32 s46, 401408
    s_mov_b32 s47, 0x20000
    s_lshl_b32 s3, s56, 1
    s_and_b32 s61, s57, 1
    s_add_u32 s3, s3, s61
    s_mul_i32 s3, s3, 6
    s_add_u32 s3, s3, s26
    s_sub_u32 s3, s3, 2
    v_lshlrev_b32 v3, 7, v1
    s_mul_i32 s61, s3, 8448
    s_mul_i32 s3, s3, 2176
    buffer_load_dword v4, v3, s[32:35], s61 offen
    s_mov_b64 exec, 0x1ffff
    buffer_load_dword v5, v3, s[44:47], s3 offen
    s_add_u32 s61, s61, 8192
    s_mov_b64 exec, 3
    buffer_load_dword v6, v3, s[32:35], s61 offen
    s_mov_b64 exec, -1
    s_branch P2_IDLE2
P2_GATE:
    s_mov_b32 s32, s18
    s_and_b32 s33, s19, 0xffff
    s_mov_b32 s34, 896
    s_mov_b32 s35, 0x20000
    v_lshrrev_b32 v3, 5, v1
    v_lshlrev_b32 v3, 4, v3
    s_and_b32 s3, s57, 1
    s_lshl_b32 s61, s3, 13
    s_lshl_b32 s44, s26, 12
    s_sub_u32 s61, s61, s44
    s_lshl_b32 s65, s56, 1
    s_add_u32 s65, s65, s3
    v_add_u32 v10, s61, v10
    v_add_u32 v11, s61, v11
    v_add_u32 v12, s61, v12
    v_add_u32 v13, s61, v13
    v_add_u32 v14, s61, v14
    v_add_u32 v15, s61, v15
    v_add_u32 v16, s61, v16
    v_add_u32 v17, s61, v17
    s_lshr_b32 s68, s48, 3
    s_mul_i32 s68, s68, 2
    s_and_b32 s3, s48, 7
    s_add_u32 s68, s68, s3
    s_sub_u32 s3, s68, 7
    s_cmp_ge_u32 s68, 7
    s_cselect_b32 s68, s3, s68
    s_sub_u32 s3, s68, 7
    s_cmp_ge_u32 s68, 7
    s_cselect_b32 s68, s3, s68
    s_lshl_b32 s3, s68, 2
    s_mov_b32 s68, 0x6543210
    s_mov_b32 s69, 0x654321
    s_lshr_b64 s[68:69], s[68:69], s3
    s_lshl_b32 s68, s68, 0
    s_bfe_u32 s37, s68, 0x40000
    s_lshl_b32 s37, s37, 7
    buffer_load_dwordx4 v[80:83], v3, s[32:35], s37 offen offset:0
    buffer_load_dwordx4 v[84:87], v3, s[32:35], s37 offen offset:32
    buffer_load_dwordx4 v[88:91], v3, s[32:35], s37 offen offset:64
    buffer_load_dwordx4 v[92:95], v3, s[32:35], s37 offen offset:96
    s_bfe_u32 s37, s68, 0x40004
    s_lshl_b32 s37, s37, 7
    buffer_load_dwordx4 v[96:99], v3, s[32:35], s37 offen offset:0
    buffer_load_dwordx4 v[100:103], v3, s[32:35], s37 offen offset:32
    buffer_load_dwordx4 v[104:107], v3, s[32:35], s37 offen offset:64
    buffer_load_dwordx4 v[108:111], v3, s[32:35], s37 offen offset:96
    s_bfe_u32 s37, s68, 0x40008
    s_lshl_b32 s37, s37, 7
    buffer_load_dwordx4 v[112:115], v3, s[32:35], s37 offen offset:0
    buffer_load_dwordx4 v[116:119], v3, s[32:35], s37 offen offset:32
    buffer_load_dwordx4 v[120:123], v3, s[32:35], s37 offen offset:64
    buffer_load_dwordx4 v[124:127], v3, s[32:35], s37 offen offset:96
    s_bfe_u32 s37, s68, 0x4000c
    s_lshl_b32 s37, s37, 7
    buffer_load_dwordx4 v[128:131], v3, s[32:35], s37 offen offset:0
    buffer_load_dwordx4 v[132:135], v3, s[32:35], s37 offen offset:32
    s_waitcnt vmcnt(0)
    ds_read_b128 v[40:43], v10 offset:0
    s_waitcnt lgkmcnt(0)
    v_mfma_f32_32x32x16_bf16 v[24:39], v[80:83], v[40:43], 0
    ds_read_b128 v[44:47], v11 offset:0
    s_waitcnt lgkmcnt(0)
    v_mfma_f32_32x32x16_bf16 v[24:39], v[84:87], v[44:47], v[24:39]
    ds_read_b128 v[40:43], v12 offset:0
    s_waitcnt lgkmcnt(0)
    v_mfma_f32_32x32x16_bf16 v[24:39], v[88:91], v[40:43], v[24:39]
    ds_read_b128 v[44:47], v13 offset:0
    s_waitcnt lgkmcnt(0)
    v_mfma_f32_32x32x16_bf16 v[24:39], v[92:95], v[44:47], v[24:39]
    ds_read_b128 v[40:43], v10 offset:16384
    s_waitcnt lgkmcnt(0)
    v_mfma_f32_32x32x16_bf16 v[24:39], v[96:99], v[40:43], v[24:39]
    ds_read_b128 v[44:47], v11 offset:16384
    s_waitcnt lgkmcnt(0)
    v_mfma_f32_32x32x16_bf16 v[24:39], v[100:103], v[44:47], v[24:39]
    ds_read_b128 v[40:43], v12 offset:16384
    s_waitcnt lgkmcnt(0)
    v_mfma_f32_32x32x16_bf16 v[24:39], v[104:107], v[40:43], v[24:39]
    ds_read_b128 v[44:47], v13 offset:16384
    s_waitcnt lgkmcnt(0)
    v_mfma_f32_32x32x16_bf16 v[24:39], v[108:111], v[44:47], v[24:39]
    ds_read_b128 v[40:43], v10 offset:32768
    s_waitcnt lgkmcnt(0)
    v_mfma_f32_32x32x16_bf16 v[24:39], v[112:115], v[40:43], v[24:39]
    ds_read_b128 v[44:47], v11 offset:32768
    s_waitcnt lgkmcnt(0)
    v_mfma_f32_32x32x16_bf16 v[24:39], v[116:119], v[44:47], v[24:39]
    ds_read_b128 v[40:43], v12 offset:32768
    s_waitcnt lgkmcnt(0)
    v_mfma_f32_32x32x16_bf16 v[24:39], v[120:123], v[40:43], v[24:39]
    ds_read_b128 v[44:47], v13 offset:32768
    s_waitcnt lgkmcnt(0)
    v_mfma_f32_32x32x16_bf16 v[24:39], v[124:127], v[44:47], v[24:39]
    ds_read_b128 v[40:43], v10 offset:49152
    s_waitcnt lgkmcnt(0)
    v_mfma_f32_32x32x16_bf16 v[24:39], v[128:131], v[40:43], v[24:39]
    ds_read_b128 v[44:47], v11 offset:49152
    s_waitcnt lgkmcnt(0)
    v_mfma_f32_32x32x16_bf16 v[24:39], v[132:135], v[44:47], v[24:39]
    buffer_load_dwordx4 v[80:83], v3, s[32:35], s37 offen offset:64
    buffer_load_dwordx4 v[84:87], v3, s[32:35], s37 offen offset:96
    s_bfe_u32 s37, s68, 0x40010
    s_lshl_b32 s37, s37, 7
    buffer_load_dwordx4 v[88:91], v3, s[32:35], s37 offen offset:0
    buffer_load_dwordx4 v[92:95], v3, s[32:35], s37 offen offset:32
    buffer_load_dwordx4 v[96:99], v3, s[32:35], s37 offen offset:64
    buffer_load_dwordx4 v[100:103], v3, s[32:35], s37 offen offset:96
    s_bfe_u32 s37, s68, 0x40014
    s_lshl_b32 s37, s37, 7
    buffer_load_dwordx4 v[104:107], v3, s[32:35], s37 offen offset:0
    buffer_load_dwordx4 v[108:111], v3, s[32:35], s37 offen offset:32
    buffer_load_dwordx4 v[112:115], v3, s[32:35], s37 offen offset:64
    buffer_load_dwordx4 v[116:119], v3, s[32:35], s37 offen offset:96
    s_bfe_u32 s37, s68, 0x40018
    s_lshl_b32 s37, s37, 7
    buffer_load_dwordx4 v[120:123], v3, s[32:35], s37 offen offset:0
    buffer_load_dwordx4 v[124:127], v3, s[32:35], s37 offen offset:32
    buffer_load_dwordx4 v[128:131], v3, s[32:35], s37 offen offset:64
    buffer_load_dwordx4 v[132:135], v3, s[32:35], s37 offen offset:96
    s_waitcnt vmcnt(0)
    ds_read_b128 v[40:43], v12 offset:49152
    s_waitcnt lgkmcnt(0)
    v_mfma_f32_32x32x16_bf16 v[24:39], v[80:83], v[40:43], v[24:39]
    ds_read_b128 v[44:47], v13 offset:49152
    s_waitcnt lgkmcnt(0)
    v_mfma_f32_32x32x16_bf16 v[24:39], v[84:87], v[44:47], v[24:39]
    ds_read_b128 v[40:43], v14 offset:0
    s_waitcnt lgkmcnt(0)
    v_mfma_f32_32x32x16_bf16 v[24:39], v[88:91], v[40:43], v[24:39]
    ds_read_b128 v[44:47], v15 offset:0
    s_waitcnt lgkmcnt(0)
    v_mfma_f32_32x32x16_bf16 v[24:39], v[92:95], v[44:47], v[24:39]
    ds_read_b128 v[40:43], v16 offset:0
    s_waitcnt lgkmcnt(0)
    v_mfma_f32_32x32x16_bf16 v[24:39], v[96:99], v[40:43], v[24:39]
    ds_read_b128 v[44:47], v17 offset:0
    s_waitcnt lgkmcnt(0)
    v_mfma_f32_32x32x16_bf16 v[24:39], v[100:103], v[44:47], v[24:39]
    ds_read_b128 v[40:43], v14 offset:16384
    s_waitcnt lgkmcnt(0)
    v_mfma_f32_32x32x16_bf16 v[24:39], v[104:107], v[40:43], v[24:39]
    ds_read_b128 v[44:47], v15 offset:16384
    s_waitcnt lgkmcnt(0)
    v_mfma_f32_32x32x16_bf16 v[24:39], v[108:111], v[44:47], v[24:39]
    ds_read_b128 v[40:43], v16 offset:16384
    s_waitcnt lgkmcnt(0)
    v_mfma_f32_32x32x16_bf16 v[24:39], v[112:115], v[40:43], v[24:39]
    ds_read_b128 v[44:47], v17 offset:16384
    s_waitcnt lgkmcnt(0)
    v_mfma_f32_32x32x16_bf16 v[24:39], v[116:119], v[44:47], v[24:39]
    ds_read_b128 v[40:43], v14 offset:32768
    s_waitcnt lgkmcnt(0)
    v_mfma_f32_32x32x16_bf16 v[24:39], v[120:123], v[40:43], v[24:39]
    ds_read_b128 v[44:47], v15 offset:32768
    s_waitcnt lgkmcnt(0)
    v_mfma_f32_32x32x16_bf16 v[24:39], v[124:127], v[44:47], v[24:39]
    ds_read_b128 v[40:43], v16 offset:32768
    s_waitcnt lgkmcnt(0)
    v_mfma_f32_32x32x16_bf16 v[24:39], v[128:131], v[40:43], v[24:39]
    ds_read_b128 v[44:47], v17 offset:32768
    s_waitcnt lgkmcnt(0)
    v_mfma_f32_32x32x16_bf16 v[24:39], v[132:135], v[44:47], v[24:39]
    s_lshl_b32 s44, s65, 8
    s_lshl_b32 s3, s26, 7
    s_add_u32 s44, s44, s3
    s_add_u32 s44, s44, 20971520
    s_mul_i32 s42, s65, 4352
    s_lshl_b32 s3, s26, 3
    s_add_u32 s42, s42, s3
    s_add_u32 s42, s42, 22368256
    v_lshlrev_b32 v3, 2, v1
    s_nop 7
    v_mul_f32 v5, 0xbfb8aa3b, v24
    v_exp_f32 v5, v5
    s_nop 0
    v_add_f32 v5, 1.0, v5
    v_rcp_f32 v5, v5
    s_mov_b64 exec, 0xffffffff
    s_nop 0
    buffer_store_dword v5, v3, s[28:31], s44 offen sc1
    s_mov_b64 exec, -1
    s_waitcnt vmcnt(0)
    s_mov_b64 exec, 1
    buffer_store_dwordx2 v[164:165], off, s[28:31], s42 sc1
    s_mov_b64 exec, -1
P2_IDLE2:
    s_barrier
    s_barrier
    s_barrier
    s_barrier
    s_barrier
    s_barrier
    s_barrier
    s_barrier
    s_barrier
    s_barrier
P1_DONE:
    s_lshr_b32 s60, s48, 4
    s_lshl_b32 s3, s27, 1
    s_add_u32 s60, s60, s3
    s_and_b32 s61, s48, 15
    s_lshl_b32 s61, s61, 2
    s_add_u32 s61, s61, s49
    s_lshl_b32 s38, s60, 18
    s_add_u32 s38, s38, 2097152
    s_lshl_b32 s41, s61, 7
    s_add_u32 s41, s41, 20971520
    v_and_b32 v6, 31, v1
    v_lshlrev_b32 v6, 2, v6
    s_lshl_b32 s3, s49, 11
    s_add_u32 s3, s3, 65536
    v_add_u32 v5, s3, v9
    s_lshl_b32 s43, s62, 12
    v_add_u32 v4, s43, v9
    v_mov_b32 v2, v4
    v_add_u32 v3, 32768, v4
    s_mov_b32 s46, 32768
    s_mov_b32 s47, 8
    s_movk_i32 s63, 0x184
    s_cmp_eq_u32 s58, 1
    s_cselect_b32 s63, 4, s63
    v_mov_b32 v106, 0
    v_mov_b32 v107, 0
    v_mov_b32 v108, 0
    v_mov_b32 v109, 0
    v_mov_b32 v110, 0
    v_mov_b32 v111, 0
    v_mov_b32 v112, 0
    v_mov_b32 v113, 0
    v_mov_b32 v114, 0
    v_mov_b32 v115, 0
    v_mov_b32 v116, 0
    v_mov_b32 v117, 0
    v_mov_b32 v118, 0
    v_mov_b32 v119, 0
    v_mov_b32 v120, 0
    v_mov_b32 v121, 0
    v_and_b32 v8, 2, v1
    v_cmp_eq_u32 vcc, 0, v8
    v_and_b32 v8, 1, v1
    v_lshlrev_b32 v8, 4, v8
    v_cndmask_b32 v7, v165, v164, vcc
    v_lshlrev_b32 v7, v8, v7
    v_and_b32 v7, 0xffff0000, v7
    ds_read_b128 v[10:13], v5
    ds_read_b128 v[14:17], v5 offset:1024
    ds_read_b128 v[58:61], v9
    ds_read_b128 v[62:65], v9 offset:1024
    ds_read_b128 v[18:21], v2 offset:0
    ds_read_b128 v[22:25], v2 offset:1024
    ds_read_b128 v[34:37], v2 offset:2048
    ds_read_b128 v[38:41], v2 offset:3072
    ds_read_b128 v[26:29], v2 offset:8192
    ds_read_b128 v[30:33], v2 offset:9216
    ds_read_b128 v[42:45], v2 offset:10240
    ds_read_b128 v[46:49], v2 offset:11264
    s_waitcnt lgkmcnt(8)
    v_mfma_f32_32x32x16_bf16 v[82:97], v[58:61], v[10:13], 0
    v_mfma_f32_32x32x16_bf16 v[82:97], v[62:65], v[14:17], v[82:97]
    s_nop 15
    v_max3_f32 v122, v82, v83, v84
    v_max3_f32 v122, v122, v85, v86
    v_max3_f32 v122, v122, v87, v88
    v_max3_f32 v122, v122, v89, v90
    v_max3_f32 v122, v122, v91, v92
    v_max3_f32 v122, v122, v93, v94
    v_max3_f32 v122, v122, v95, v96
    v_max_f32 v122, v122, v97
    v_mov_b32 v123, v122
    s_nop 1
    v_permlane32_swap_b32 v122, v123
    s_nop 1
    v_max_f32 v122, v122, v123
    v_mov_b32 v123, 0
    v_cvt_pk_bf16_f32 v122, -v122, v123
    v_cndmask_b32 v16, v16, v122, s[52:53]
    s_waitcnt lgkmcnt(0)
    s_nop 0
    v_mfma_f32_32x32x16_bf16 v[66:81], v[18:21], v[10:13], 0
    v_mfma_f32_32x32x16_bf16 v[66:81], v[22:25], v[14:17], v[66:81]
    v_mov_b32 v102, 0
    v_mov_b32 v62, 0
    v_mov_b32 v103, 0
    v_mov_b32 v63, 0
    v_mov_b32 v104, 0
    v_mov_b32 v64, 0
    v_mov_b32 v105, 0
    v_mov_b32 v65, 0
    s_nop 7
.p2align 6
A_LOOP:
    s_waitcnt lgkmcnt(0)
    s_setprio 1
    v_exp_f32 v66, v66
    v_exp_f32 v67, v67
    v_mfma_f32_32x32x16_bf16 v[106:121], v[62:65], v[102:105], v[106:121]
    ds_read_b128 v[18:21], v2 offset:16384
    ds_read_b128 v[22:25], v2 offset:17408
    v_exp_f32 v68, v68
    v_exp_f32 v69, v69
    v_cvt_pk_bf16_f32 v98, v66, v67
    v_exp_f32 v70, v70
    v_exp_f32 v71, v71
    v_cvt_pk_bf16_f32 v99, v68, v69
    v_mfma_f32_32x32x16_bf16 v[82:97], v[26:29], v[10:13], 0
    ds_read_b128 v[50:53], v2 offset:18432
    ds_read_b128 v[54:57], v2 offset:19456
    v_exp_f32 v72, v72
    v_exp_f32 v73, v73
    v_cvt_pk_bf16_f32 v100, v70, v71
    v_exp_f32 v74, v74
    v_cvt_pk_bf16_f32 v101, v72, v73
    v_exp_f32 v75, v75
    v_mfma_f32_32x32x16_bf16 v[82:97], v[30:33], v[14:17], v[82:97]
    v_exp_f32 v76, v76
    v_exp_f32 v77, v77
    v_cvt_pk_bf16_f32 v102, v74, v75
    v_exp_f32 v78, v78
    v_exp_f32 v79, v79
    v_cvt_pk_bf16_f32 v103, v76, v77
    v_mfma_f32_32x32x16_bf16 v[106:121], v[34:37], v[98:101], v[106:121]
    v_exp_f32 v80, v80
    v_exp_f32 v81, v81
    v_cvt_pk_bf16_f32 v104, v78, v79
    v_cvt_pk_bf16_f32 v105, v80, v81
    s_waitcnt lgkmcnt(0)
    s_setprio 0
    v_exp_f32 v82, v82
    v_exp_f32 v83, v83
    v_mfma_f32_32x32x16_bf16 v[106:121], v[38:41], v[102:105], v[106:121]
    ds_read_b128 v[26:29], v2 offset:24576
    ds_read_b128 v[30:33], v2 offset:25600
    v_exp_f32 v84, v84
    v_exp_f32 v85, v85
    v_cvt_pk_bf16_f32 v98, v82, v83
    v_exp_f32 v86, v86
    v_exp_f32 v87, v87
    v_cvt_pk_bf16_f32 v99, v84, v85
    v_mfma_f32_32x32x16_bf16 v[66:81], v[18:21], v[10:13], 0
    ds_read_b128 v[58:61], v2 offset:26624
    ds_read_b128 v[62:65], v2 offset:27648
    v_exp_f32 v88, v88
    v_exp_f32 v89, v89
    v_cvt_pk_bf16_f32 v100, v86, v87
    v_exp_f32 v90, v90
    v_cvt_pk_bf16_f32 v101, v88, v89
    v_exp_f32 v91, v91
    v_mfma_f32_32x32x16_bf16 v[66:81], v[22:25], v[14:17], v[66:81]
    s_bitcmp1_b32 s63, s47
    s_cbranch_scc1 A_RARE1
A_BACK1:
    v_exp_f32 v92, v92
    v_exp_f32 v93, v93
    v_cvt_pk_bf16_f32 v102, v90, v91
    v_exp_f32 v94, v94
    v_exp_f32 v95, v95
    v_cvt_pk_bf16_f32 v103, v92, v93
    v_mfma_f32_32x32x16_bf16 v[106:121], v[42:45], v[98:101], v[106:121]
    v_exp_f32 v96, v96
    v_exp_f32 v97, v97
    v_cvt_pk_bf16_f32 v104, v94, v95
    v_cvt_pk_bf16_f32 v105, v96, v97
    s_waitcnt lgkmcnt(0)
    s_barrier
    s_setprio 3
    v_exp_f32 v66, v66
    v_exp_f32 v67, v67
    v_mfma_f32_32x32x16_bf16 v[106:121], v[46:49], v[102:105], v[106:121]
    ds_read_b128 v[18:21], v3 offset:0
    ds_read_b128 v[22:25], v3 offset:1024
    v_exp_f32 v68, v68
    v_exp_f32 v69, v69
    v_cvt_pk_bf16_f32 v98, v66, v67
    v_exp_f32 v70, v70
    v_exp_f32 v71, v71
    v_cvt_pk_bf16_f32 v99, v68, v69
    v_mfma_f32_32x32x16_bf16 v[82:97], v[26:29], v[10:13], 0
    ds_read_b128 v[34:37], v3 offset:2048
    ds_read_b128 v[38:41], v3 offset:3072
    v_exp_f32 v72, v72
    v_exp_f32 v73, v73
    v_cvt_pk_bf16_f32 v100, v70, v71
    v_exp_f32 v74, v74
    v_cvt_pk_bf16_f32 v101, v72, v73
    v_exp_f32 v75, v75
    v_mfma_f32_32x32x16_bf16 v[82:97], v[30:33], v[14:17], v[82:97]
    v_exp_f32 v76, v76
    v_exp_f32 v77, v77
    v_cvt_pk_bf16_f32 v102, v74, v75
    v_exp_f32 v78, v78
    v_exp_f32 v79, v79
    v_cvt_pk_bf16_f32 v103, v76, v77
    v_mfma_f32_32x32x16_bf16 v[106:121], v[50:53], v[98:101], v[106:121]
    v_exp_f32 v80, v80
    v_exp_f32 v81, v81
    v_cvt_pk_bf16_f32 v104, v78, v79
    v_cvt_pk_bf16_f32 v105, v80, v81
    s_waitcnt lgkmcnt(0)
    s_setprio 2
    v_exp_f32 v82, v82
    v_exp_f32 v83, v83
    v_mfma_f32_32x32x16_bf16 v[106:121], v[54:57], v[102:105], v[106:121]
    ds_read_b128 v[26:29], v3 offset:8192
    ds_read_b128 v[30:33], v3 offset:9216
    v_exp_f32 v84, v84
    v_exp_f32 v85, v85
    v_cvt_pk_bf16_f32 v98, v82, v83
    v_exp_f32 v86, v86
    v_exp_f32 v87, v87
    v_cvt_pk_bf16_f32 v99, v84, v85
    v_mfma_f32_32x32x16_bf16 v[66:81], v[18:21], v[10:13], 0
    ds_read_b128 v[42:45], v3 offset:10240
    ds_read_b128 v[46:49], v3 offset:11264
    v_exp_f32 v88, v88
    v_exp_f32 v89, v89
    v_cvt_pk_bf16_f32 v100, v86, v87
    v_exp_f32 v90, v90
    v_cvt_pk_bf16_f32 v101, v88, v89
    v_exp_f32 v91, v91
    v_mfma_f32_32x32x16_bf16 v[66:81], v[22:25], v[14:17], v[66:81]
    s_bitcmp1_b32 s63, s47
    s_cbranch_scc1 A_RARE3
A_BACK3:
    v_exp_f32 v92, v92
    v_exp_f32 v93, v93
    v_cvt_pk_bf16_f32 v102, v90, v91
    v_exp_f32 v94, v94
    v_exp_f32 v95, v95
    v_cvt_pk_bf16_f32 v103, v92, v93
    v_mfma_f32_32x32x16_bf16 v[106:121], v[58:61], v[98:101], v[106:121]
    v_exp_f32 v96, v96
    v_exp_f32 v97, v97
    v_cvt_pk_bf16_f32 v104, v94, v95
    v_cvt_pk_bf16_f32 v105, v96, v97
    v_mov_b32 v2, v3
    s_add_u32 s46, s46, 32768
    s_cmp_eq_u32 s46, 98304
    s_cselect_b32 s46, 0, s46
    v_add_u32 v3, s46, v4
    s_sub_u32 s47, s47, 1
    s_cmp_lg_u32 s47, 0
    s_cbranch_scc1 A_LOOP
    v_mfma_f32_32x32x16_bf16 v[106:121], v[62:65], v[102:105], v[106:121]
    s_lshl_b32 s43, s49, 13
    s_add_u32 s43, s43, 32768
    v_add_u32 v5, s43, v9
    s_lshl_b32 s43, s61, 4
    s_add_u32 s43, s43, s60
    s_lshl_b32 s43, s43, 1
    s_add_u32 s43, s43, s62
    s_lshl_b32 s43, s43, 10
    s_add_u32 s43, s43, 14680064
    s_mov_b32 s44, 0x30800000
    s_mov_b32 s45, 0x5d800000
    s_waitcnt lgkmcnt(0)
    s_nop 1
    s_cmp_eq_u32 s62, 1
    s_cbranch_scc1 A_FIN1
A_FIN0:
    ds_write_b128 v5, v[114:117] offset:0
    ds_write_b128 v5, v[118:121] offset:1024
    ds_write_b128 v5, v[110:113] offset:2048
    s_waitcnt lgkmcnt(0)
    s_barrier
    ds_read_b128 v[66:69], v5 offset:4096
    ds_read_b128 v[70:73], v5 offset:5120
    s_waitcnt lgkmcnt(0)
    v_add_f32 v113, v113, v73
    v_add_f32 v106, v106, v66
    v_add_f32 v107, v107, v67
    v_add_f32 v108, v108, v68
    v_add_f32 v109, v109, v69
    v_add_f32 v110, v110, v70
    v_add_f32 v111, v111, v71
    v_add_f32 v112, v112, v72
    v_mov_b32 v122, v113
    v_mov_b32 v123, v113
    v_mov_b32 v113, 0
    v_mov_b32 v121, 0
    v_permlane32_swap_b32 v123, v122
    v_mul_f32 v124, 0, v106
    v_mul_f32 v125, 0, v107
    v_fmac_f32 v124, 0, v108
    v_fmac_f32 v125, 0, v109
    v_fmac_f32 v124, 0, v110
    v_fmac_f32 v125, 0, v111
    v_fmac_f32 v124, 0, v112
    v_add_f32 v124, v124, v125
    v_cmp_le_f32 s[66:67], s44, v123
    v_cmp_ge_f32 vcc, s45, v123
    v_cmp_eq_f32 s[64:65], 0, v124
    s_and_b64 s[66:67], s[66:67], vcc
    s_and_b64 s[64:65], s[64:65], s[66:67]
    s_cmp_eq_u64 s[64:65], -1
    s_cbranch_scc0 A_FALL
A_NORM0:
    v_rcp_f32 v124, v123
    s_waitcnt vmcnt(0)
    v_mul_f32 v124, v124, v140
    v_mul_f32 v106, v106, v124
    v_mul_f32 v107, v107, v124
    v_mul_f32 v108, v108, v124
    v_mul_f32 v109, v109, v124
    v_mul_f32 v110, v110, v124
    v_mul_f32 v111, v111, v124
    v_mul_f32 v112, v112, v124
    v_cvt_pk_bf16_f32 v98, v106, v107
    v_cvt_pk_bf16_f32 v99, v108, v109
    v_cvt_pk_bf16_f32 v100, v110, v111
    v_cvt_pk_bf16_f32 v101, v112, v113
    v_or_b32 v101, v101, v7
    buffer_store_dwordx4 v[98:101], v9, s[28:31], s43 offen sc1
    s_endpgm
A_FIN1:
    ds_write_b128 v5, v[106:109] offset:4096
    ds_write_b128 v5, v[110:113] offset:5120
    s_waitcnt lgkmcnt(0)
    s_barrier
    ds_read_b128 v[66:69], v5 offset:0
    ds_read_b128 v[70:73], v5 offset:1024
    ds_read_b128 v[74:77], v5 offset:2048
    s_waitcnt lgkmcnt(0)
    v_add_f32 v113, v113, v77
    v_add_f32 v114, v114, v66
    v_add_f32 v115, v115, v67
    v_add_f32 v116, v116, v68
    v_add_f32 v117, v117, v69
    v_add_f32 v118, v118, v70
    v_add_f32 v119, v119, v71
    v_add_f32 v120, v120, v72
    v_mov_b32 v122, v113
    v_mov_b32 v123, v113
    v_mov_b32 v113, 0
    v_mov_b32 v121, 0
    v_permlane32_swap_b32 v123, v122
    v_mul_f32 v124, 0, v114
    v_mul_f32 v125, 0, v115
    v_fmac_f32 v124, 0, v116
    v_fmac_f32 v125, 0, v117
    v_fmac_f32 v124, 0, v118
    v_fmac_f32 v125, 0, v119
    v_fmac_f32 v124, 0, v120
    v_add_f32 v124, v124, v125
    v_cmp_le_f32 s[66:67], s44, v123
    v_cmp_ge_f32 vcc, s45, v123
    v_cmp_eq_f32 s[64:65], 0, v124
    s_and_b64 s[66:67], s[66:67], vcc
    s_and_b64 s[64:65], s[64:65], s[66:67]
    s_cmp_eq_u64 s[64:65], -1
    s_cbranch_scc0 A_FALL
A_NORM1:
    v_rcp_f32 v124, v123
    s_waitcnt vmcnt(0)
    v_mul_f32 v124, v124, v140
    v_mul_f32 v114, v114, v124
    v_mul_f32 v115, v115, v124
    v_mul_f32 v116, v116, v124
    v_mul_f32 v117, v117, v124
    v_mul_f32 v118, v118, v124
    v_mul_f32 v119, v119, v124
    v_mul_f32 v120, v120, v124
    v_cvt_pk_bf16_f32 v98, v114, v115
    v_cvt_pk_bf16_f32 v99, v116, v117
    v_cvt_pk_bf16_f32 v100, v118, v119
    v_cvt_pk_bf16_f32 v101, v120, v121
    v_or_b32 v101, v101, v7
    buffer_store_dwordx4 v[98:101], v9, s[28:31], s43 offen sc1
    s_endpgm
A_RARE1:
    s_cmp_lg_u32 s47, 8
    s_cbranch_scc1 AR_36
    s_cmp_eq_u32 s62, 0
    s_cbranch_scc1 A_XFLAG
    buffer_store_dwordx4 v[144:147], v9, s[28:31], s40 offen offset:0 sc1
    buffer_store_dwordx4 v[148:151], v9, s[28:31], s40 offen offset:1024 sc1
    s_branch A_BACK1
AR_36:
    s_branch A_BACK1
A_RARE3:
    s_cmp_lg_u32 s47, 8
    s_cbranch_scc1 AR_38
    s_cmp_eq_u32 s62, 0
    s_cbranch_scc1 A_BACK3
    buffer_store_dwordx4 v[152:155], v9, s[28:31], s42 offen offset:0 sc1
    buffer_store_dwordx4 v[156:159], v9, s[28:31], s42 offen offset:1024 sc1
    s_branch A_BACK3
AR_38:
    s_cmp_lg_u32 s47, 7
    s_cbranch_scc1 AR_39
    s_cmp_eq_u32 s62, 0
    s_cbranch_scc1 A_BACK3
    s_waitcnt vmcnt(0)
    s_mov_b64 exec, 1
    buffer_store_dwordx2 v[164:165], off, s[28:31], s59 sc1
    s_mov_b64 exec, -1
    s_branch A_BACK3
AR_39:
    s_cmp_lg_u32 s47, 2
    s_cbranch_scc1 A_BACK3
    buffer_load_dword v140, v6, s[28:31], s41 offen sc1
    s_branch A_BACK3
A_XFLAG:
    s_waitcnt vmcnt(0)
    s_mov_b64 exec, 1
    buffer_store_dwordx2 v[164:165], off, s[28:31], s59 sc1
    s_mov_b64 exec, -1
    s_branch A_BACK1
A_FALL:
    v_cndmask_b32 v16, v16, 0, s[52:53]
    v_mov_b32 v128, 0xff800000
    s_mov_b32 s44, s38
    s_mov_b32 s47, 64
A_FL1:
    buffer_load_dwordx4 v[18:21], v9, s[28:31], s44 offen sc1
    buffer_load_dwordx4 v[22:25], v9, s[28:31], s44 offen offset:1024 sc1
    s_waitcnt vmcnt(0)
    v_mfma_f32_32x32x16_bf16 v[66:81], v[18:21], v[10:13], 0
    v_mfma_f32_32x32x16_bf16 v[66:81], v[22:25], v[14:17], v[66:81]
    s_nop 15
    v_max3_f32 v129, v66, v67, v68
    v_max3_f32 v129, v129, v69, v70
    v_max3_f32 v129, v129, v71, v72
    v_max3_f32 v129, v129, v73, v74
    v_max3_f32 v129, v129, v75, v76
    v_max3_f32 v129, v129, v77, v78
    v_max3_f32 v129, v129, v79, v80
    v_max_f32 v129, v129, v81
    v_max_f32 v128, v128, v129
    s_add_u32 s44, s44, 4096
    s_sub_u32 s47, s47, 1
    s_cmp_lg_u32 s47, 0
    s_cbranch_scc1 A_FL1
    v_mov_b32 v129, v128
    s_nop 1
    v_permlane32_swap_b32 v128, v129
    s_nop 1
    v_max_f32 v128, v128, v129
    v_mov_b32 v106, 0
    v_mov_b32 v107, 0
    v_mov_b32 v108, 0
    v_mov_b32 v109, 0
    v_mov_b32 v110, 0
    v_mov_b32 v111, 0
    v_mov_b32 v112, 0
    v_mov_b32 v113, 0
    v_mov_b32 v114, 0
    v_mov_b32 v115, 0
    v_mov_b32 v116, 0
    v_mov_b32 v117, 0
    v_mov_b32 v118, 0
    v_mov_b32 v119, 0
    v_mov_b32 v120, 0
    v_mov_b32 v121, 0
    s_mov_b32 s44, s38
    s_mov_b32 s47, 64
A_FL2:
    buffer_load_dwordx4 v[18:21], v9, s[28:31], s44 offen sc1
    buffer_load_dwordx4 v[22:25], v9, s[28:31], s44 offen offset:1024 sc1
    buffer_load_dwordx4 v[34:37], v9, s[28:31], s44 offen offset:2048 sc1
    buffer_load_dwordx4 v[38:41], v9, s[28:31], s44 offen offset:3072 sc1
    s_waitcnt vmcnt(0)
    v_mfma_f32_32x32x16_bf16 v[66:81], v[18:21], v[10:13], 0
    v_mfma_f32_32x32x16_bf16 v[66:81], v[22:25], v[14:17], v[66:81]
    s_nop 15
    v_sub_f32 v66, v66, v128
    v_sub_f32 v67, v67, v128
    v_sub_f32 v68, v68, v128
    v_sub_f32 v69, v69, v128
    v_sub_f32 v70, v70, v128
    v_sub_f32 v71, v71, v128
    v_sub_f32 v72, v72, v128
    v_sub_f32 v73, v73, v128
    v_sub_f32 v74, v74, v128
    v_sub_f32 v75, v75, v128
    v_sub_f32 v76, v76, v128
    v_sub_f32 v77, v77, v128
    v_sub_f32 v78, v78, v128
    v_sub_f32 v79, v79, v128
    v_sub_f32 v80, v80, v128
    v_sub_f32 v81, v81, v128
    v_exp_f32 v66, v66
    v_exp_f32 v67, v67
    v_exp_f32 v68, v68
    v_exp_f32 v69, v69
    v_exp_f32 v70, v70
    v_exp_f32 v71, v71
    v_exp_f32 v72, v72
    v_exp_f32 v73, v73
    v_exp_f32 v74, v74
    v_exp_f32 v75, v75
    v_exp_f32 v76, v76
    v_exp_f32 v77, v77
    v_exp_f32 v78, v78
    v_exp_f32 v79, v79
    v_exp_f32 v80, v80
    v_exp_f32 v81, v81
    s_nop 0
    v_cvt_pk_bf16_f32 v98, v66, v67
    v_cvt_pk_bf16_f32 v99, v68, v69
    v_cvt_pk_bf16_f32 v100, v70, v71
    v_cvt_pk_bf16_f32 v101, v72, v73
    v_cvt_pk_bf16_f32 v102, v74, v75
    v_cvt_pk_bf16_f32 v103, v76, v77
    v_cvt_pk_bf16_f32 v104, v78, v79
    v_cvt_pk_bf16_f32 v105, v80, v81
    s_nop 1
    v_mfma_f32_32x32x16_bf16 v[106:121], v[34:37], v[98:101], v[106:121]
    v_mfma_f32_32x32x16_bf16 v[106:121], v[38:41], v[102:105], v[106:121]
    s_add_u32 s44, s44, 4096
    s_sub_u32 s47, s47, 1
    s_cmp_lg_u32 s47, 0
    s_cbranch_scc1 A_FL2
    s_nop 15
    v_mov_b32 v122, v113
    v_mov_b32 v123, v113
    v_mov_b32 v113, 0
    v_mov_b32 v121, 0
    v_permlane32_swap_b32 v123, v122
    s_cmp_eq_u32 s62, 1
    s_cbranch_scc1 A_NORM1
    s_branch A_NORM0
L_CODE_END:
.section .rodata,"a"
.p2align 6
.amdhsa_kernel gated_mix__mha_block__geglu_ffn__prompt_kernel
  .amdhsa_next_free_vgpr 168
  .amdhsa_next_free_sgpr 102
  .amdhsa_accum_offset 168
  .amdhsa_group_segment_fixed_size 0
  .amdhsa_kernarg_size 88
  .amdhsa_user_sgpr_count 2
  .amdhsa_user_sgpr_kernarg_segment_ptr 1
  .amdhsa_system_sgpr_workgroup_id_x 1
.end_amdhsa_kernel
```
